```python
import torch

def _softmax(x, axis=-1):
    return torch.softmax(x, dim=axis)
def _gelu(x):
    return torch.nn.functional.gelu(x, approximate="tanh")
def _silu(x):
    return torch.nn.functional.silu(x)
def _sigmoid(x):
    return torch.sigmoid(x)
def _layernorm(x, axis=-1, eps=1e-5):
    m = x.mean(dim=axis, keepdim=True)
    v = x.var(dim=axis, keepdim=True, unbiased=False)
    return (x - m) / torch.sqrt(v + eps)
def _scatter_add(tgt, idx, src, axis=0):
    return tgt.clone().index_add_(axis, idx, src)
def _segment_sum(src, seg, n):
    out = torch.zeros((n,) + src.shape[1:], dtype=src.dtype)
    return out.index_add_(0, seg, src)
def _pad(x, pw):
    flat = tuple(v for pair in reversed(pw) for v in pair)
    return torch.nn.functional.pad(x, flat)

kernel_name = 'parallel_sum__sliding_block_cached__dense_activation_gelu__decode'

def setup_inputs():

    _w = (lambda a: (lambda t: t.to(torch.bfloat16) if t.is_floating_point() else t)(torch.as_tensor(a)))
    def _A_setup():
        B, Sq, D = 1, 1, 448
        Hq, Hkv, Sk, Dh = 16, 8, 65536, 256
        assert Hq % Hkv == 0, (Hq, Hkv)
        return {
            "x": _w((lambda *s: torch.randn(*s, dtype=torch.bfloat16) * 0.05)(B, Sq, D)),
            "k_cache": _w((lambda *s: torch.randn(*s, dtype=torch.bfloat16) * 3.2)(B, Hkv, Sk, Dh)),
            "v_cache": _w((lambda *s: torch.randn(*s, dtype=torch.bfloat16) * 0.8)(B, Hkv, Sk, Dh)),
            "wq": _w((lambda *s: torch.randn(*s, dtype=torch.bfloat16) * 3.2)(D, Hq * Dh) * (D ** -0.5)),
            "wo": _w((lambda *s: torch.randn(*s, dtype=torch.bfloat16) * 0.8)(Hq * Dh, D) * ((Hq * Dh) ** -0.5)),
        }
    _A_in = _A_setup()

    def _B_setup():
        B, S, D, F = 1, 1, 448, 1792
        return {
            "x": _w((lambda *s: torch.randn(*s, dtype=torch.bfloat16) * 0.05)(B, S, D)),
            "w1": _w((lambda *s: torch.randn(*s, dtype=torch.bfloat16) * 3.2)(D, F) * (D ** -0.5)),
            "b1": _w((lambda *s: torch.randn(*s, dtype=torch.bfloat16) * 3.2)(F) * 0.01),
            "w2": _w((lambda *s: torch.randn(*s, dtype=torch.bfloat16) * 0.2)(F, D) * (F ** -0.5)),
            "b2": _w((lambda *s: torch.randn(*s, dtype=torch.bfloat16) * 0.2)(D) * 0.01),
        }
    _B_in = _B_setup()

    return {
        "A_x": _A_in["x"],
        "A_k_cache": _A_in["k_cache"],
        "A_v_cache": _A_in["v_cache"],
        "A_wq": _A_in["wq"],
        "A_wo": _A_in["wo"],
        "B_x": _B_in["x"],
        "B_w1": _B_in["w1"],
        "B_b1": _B_in["b1"],
        "B_w2": _B_in["w2"],
        "B_b2": _B_in["b2"],
    }

def reference(A_x, A_k_cache, A_v_cache, A_wq, A_wo, B_x, B_w1, B_b1, B_w2, B_b2):
    def _A_ref(x, k_cache, v_cache, wq, wo):
        B, Sq, D = x.shape
        Hq, Dh = 16, 256
        Hkv, Sk = k_cache.shape[1], k_cache.shape[2]
        W = min(4096, max(256, Sk // 4))
        rep = Hq // Hkv
        q = (lambda x, *d: x.permute(*d))((x @ wq).reshape(B, Sq, Hq, Dh), 0, 2, 1, 3)
        k = (lambda x, n, axis: torch.repeat_interleave(x, n, dim=axis))(k_cache[:, :, Sk - W:, :], rep, axis=1)
        v = (lambda x, n, axis: torch.repeat_interleave(x, n, dim=axis))(v_cache[:, :, Sk - W:, :], rep, axis=1)
        scores = torch.einsum("bhqd,bhkd->bhqk", q, k) * (Dh ** -0.5)
        p = _softmax(scores, axis=-1)
        o = torch.einsum("bhqk,bhkd->bhqd", p, v)
        return (lambda x, *d: x.permute(*d))(o, 0, 2, 1, 3).reshape(B, Sq, Hq * Dh) @ wo

    def _B_ref(x, w1, b1, w2, b2):
        h = torch.einsum("bsd,df->bsf", x, w1) + b1
        h = _gelu(h)
        return torch.einsum("bsf,fd->bsd", h, w2) + b2

    x = A_x
    xn = _layernorm(x, axis=-1)
    return x + _A_ref(xn, A_k_cache, A_v_cache, A_wq, A_wo) + _B_ref(xn, B_w1, B_b1, B_w2, B_b2)
```

```asm
; @launch grid=(256,1,1) block=(384,1,1) lds=159040
.amdgcn_target "amdgcn-amd-amdhsa--gfx950"
.text
.globl parallel_sum__sliding_block_cached__dense_activation_gelu__decode_kernel
.p2align 8
.type parallel_sum__sliding_block_cached__dense_activation_gelu__decode_kernel,@function
parallel_sum__sliding_block_cached__dense_activation_gelu__decode_kernel:
s_load_dwordx16 s[4:19], s[0:1], 0
s_load_dwordx8 s[20:27], s[0:1], 64
s_load_dwordx2 s[28:29], s[0:1], 96
s_cmp_ge_u32 s2, 256
s_cbranch_scc1 L_end
v_lshrrev_b32 v1, 6, v0
v_and_b32 v0, 63, v0
v_readfirstlane_b32 s30, v1
s_and_b32 s31, s2, 7
s_lshr_b32 s32, s2, 3
s_lshl_b32 s64, s31, 5
s_add_u32 s64, s64, s32
s_mov_b32 s59, 0
s_getreg_b32 s34, hwreg(HW_REG_XCC_ID, 0, 4)
v_mov_b32 v15, 158848
s_cmp_eq_u32 s30, 4
s_cbranch_scc1 L_loader
L_cpro:
s_lshl_b32 s51, s32, 3
s_add_u32 s51, s51, s31
s_min_u32 s53, s51, 55
v_lshrrev_b32 v2, 3, v0
v_and_b32 v3, 7, v0
v_mov_b32 v63, 0
v_mov_b32 v104, 0
s_cmp_eq_u32 s30, 5
s_cbranch_scc1 L_f_par
s_cmp_lg_u32 s30, 0
s_cbranch_scc1 L_c123_pre
s_and_b32 s46, s32, 3
s_mul_i32 s46, s46, 112
s_lshl_b32 s44, s46, 13
s_lshr_b32 s47, s32, 2
s_lshl_b32 s47, s47, 7
s_add_u32 s44, s44, s47
s_lshl_b32 s47, s31, 10
s_add_u32 s44, s44, s47
s_movk_i32 s45, 8192
s_mov_b32 s47, 3670016
s_waitcnt lgkmcnt(0)
s_mov_b32 s48, s10
s_mov_b32 s49, s11
s_branch L_c01_ld
L_f_par:
s_and_b32 s46, s32, 7
s_mul_i32 s46, s46, 56
s_mul_i32 s44, s46, 3584
s_lshl_b32 s47, s31, 2
s_lshr_b32 s48, s32, 3
s_add_u32 s47, s47, s48
s_min_u32 s47, s47, 27
s_lshl_b32 s47, s47, 7
s_add_u32 s44, s44, s47
s_movk_i32 s45, 3584
s_mov_b32 s47, 1605632
s_waitcnt lgkmcnt(0)
s_mov_b32 s48, s16
s_mov_b32 s49, s17
L_c01_ld:
s_mov_b32 s40, s4
s_and_b32 s41, s5, 0xffff
s_movk_i32 s42, 896
s_mov_b32 s43, 0x20000
v_lshlrev_b32 v4, 4, v0
buffer_load_dwordx4 v[16:19], v4, s[40:43], 0 offen
s_add_u32 s36, s48, s44
s_addc_u32 s37, s49, 0
s_and_b32 s37, s37, 0xffff
s_sub_u32 s38, s47, s44
s_mov_b32 s39, 0x20000
s_cmp_eq_u32 s30, 5
s_cselect_b32 s60, s31, 0
s_cmp_eq_u32 s60, 7
s_cselect_b32 s38, 0, s38
v_mul_lo_u32 v5, v2, s45
v_lshl_add_u32 v5, v3, 4, v5
s_lshl_b32 s45, s45, 3
s_mov_b32 s50, 0
s_cmp_eq_u32 s30, 5
s_cbranch_scc1 L_aux_bar
buffer_load_dwordx4 v[64:67], v5, s[36:39], s50 offen nt
s_add_u32 s50, s50, s45
buffer_load_dwordx4 v[68:71], v5, s[36:39], s50 offen nt
s_add_u32 s50, s50, s45
buffer_load_dwordx4 v[72:75], v5, s[36:39], s50 offen nt
s_add_u32 s50, s50, s45
buffer_load_dwordx4 v[76:79], v5, s[36:39], s50 offen nt
s_add_u32 s50, s50, s45
buffer_load_dwordx4 v[80:83], v5, s[36:39], s50 offen nt
s_add_u32 s50, s50, s45
buffer_load_dwordx4 v[84:87], v5, s[36:39], s50 offen nt
s_add_u32 s50, s50, s45
buffer_load_dwordx4 v[88:91], v5, s[36:39], s50 offen nt
s_add_u32 s50, s50, s45
buffer_load_dwordx4 v[92:95], v5, s[36:39], s50 offen nt
s_add_u32 s50, s50, s45
buffer_load_dwordx4 v[96:99], v5, s[36:39], s50 offen nt
s_add_u32 s50, s50, s45
buffer_load_dwordx4 v[100:103], v5, s[36:39], s50 offen nt
s_add_u32 s50, s50, s45
buffer_load_dwordx4 v[104:107], v5, s[36:39], s50 offen nt
s_add_u32 s50, s50, s45
buffer_load_dwordx4 v[108:111], v5, s[36:39], s50 offen nt
s_add_u32 s50, s50, s45
buffer_load_dwordx4 v[112:115], v5, s[36:39], s50 offen nt
s_add_u32 s50, s50, s45
buffer_load_dwordx4 v[116:119], v5, s[36:39], s50 offen nt
s_add_u32 s50, s50, s45
global_load_dword v63, v63, s[28:29] sc1
s_branch L_c_bar0
L_aux_bar:
s_barrier
buffer_load_dwordx4 v[64:67], v5, s[36:39], s50 offen nt
s_add_u32 s50, s50, s45
buffer_load_dwordx4 v[68:71], v5, s[36:39], s50 offen nt
s_add_u32 s50, s50, s45
buffer_load_dwordx4 v[72:75], v5, s[36:39], s50 offen nt
s_add_u32 s50, s50, s45
buffer_load_dwordx4 v[76:79], v5, s[36:39], s50 offen nt
s_add_u32 s50, s50, s45
buffer_load_dwordx4 v[80:83], v5, s[36:39], s50 offen nt
s_add_u32 s50, s50, s45
buffer_load_dwordx4 v[84:87], v5, s[36:39], s50 offen nt
s_add_u32 s50, s50, s45
buffer_load_dwordx4 v[88:91], v5, s[36:39], s50 offen nt
s_add_u32 s50, s50, s45
global_load_dword v63, v63, s[28:29] sc1
s_min_u32 s57, s64, 223
s_lshl_b32 s57, s57, 4
v_and_b32 v6, 3, v0
v_lshl_add_u32 v6, v6, 2, s57
global_load_dword v60, v6, s[18:19]
s_branch L_ln
L_c123_pre:
s_cmp_lg_u32 s30, 3
s_cbranch_scc1 L_nopf
s_getpc_b64 s[60:61]
L_pf:
v_lshlrev_b32 v4, 7, v0
v_min_u32 v5, L_end-L_pf, v4
global_load_dword v6, v5, s[60:61]
v_add_u32 v4, 0x2000, v4
v_min_u32 v5, L_end-L_pf, v4
global_load_dword v7, v5, s[60:61]
L_nopf:
s_waitcnt lgkmcnt(0)
global_load_dword v63, v63, s[28:29] sc1
s_cmp_eq_u32 s30, 2
s_cbranch_scc1 L_c2_pre
s_branch L_c_bar0
L_c2_pre:
s_lshl_b32 s60, s31, 13
s_lshl_b32 s61, s32, 8
s_add_u32 s60, s60, s61
s_add_u32 s60, s60, 65536
s_lshl_b32 s61, s64, 9
s_add_u32 s61, s61, 261888
v_mov_b32 v5, s60
v_mov_b32 v6, s61
v_cmp_gt_u32 vcc, 2, v0
v_lshlrev_b32 v4, 7, v0
s_nop 0
v_cndmask_b32 v5, v6, v5, vcc
v_add_u32 v4, v5, v4
s_mov_b64 exec, 0x3f
global_load_dword v8, v4, s[28:29]
s_mov_b64 exec, -1
L_c_bar0:
s_barrier
s_cmp_eq_u32 s30, 0
s_cbranch_scc1 L_ln
s_branch L_common
L_ln:
s_waitcnt vmcnt(9)
v_lshlrev_b32 v20, 16, v16
v_and_b32 v21, 0xffff0000, v16
v_lshlrev_b32 v22, 16, v17
v_and_b32 v23, 0xffff0000, v17
v_lshlrev_b32 v24, 16, v18
v_and_b32 v25, 0xffff0000, v18
v_lshlrev_b32 v26, 16, v19
v_and_b32 v27, 0xffff0000, v19
v_add_f32 v28, v20, v21
v_add_f32 v29, v22, v23
v_add_f32 v30, v24, v25
v_add_f32 v31, v26, v27
v_add_f32 v28, v28, v29
v_add_f32 v30, v30, v31
v_add_f32 v28, v28, v30
s_nop 1
v_add_f32_dpp v28, v28, v28 quad_perm:[1,0,3,2] row_mask:0xf bank_mask:0xf
s_nop 1
v_add_f32_dpp v28, v28, v28 quad_perm:[2,3,0,1] row_mask:0xf bank_mask:0xf
s_nop 1
v_add_f32_dpp v28, v28, v28 row_ror:4 row_mask:0xf bank_mask:0xf
s_nop 1
v_add_f32_dpp v28, v28, v28 row_ror:8 row_mask:0xf bank_mask:0xf
v_mov_b32 v29, v28
s_nop 1
v_permlane16_swap_b32 v28, v29
s_nop 0
v_add_f32 v28, v28, v29
v_mov_b32 v29, v28
s_nop 1
v_permlane32_swap_b32 v28, v29
s_nop 0
v_add_f32 v28, v28, v29
s_mov_b32 s60, 0x3b124925
s_mov_b32 s61, 0x43e00000
v_mul_f32 v29, s60, v28
v_fma_f32 v30, -v29, s61, v28
v_fma_f32 v29, v30, s60, v29
v_mov_b32 v30, 0
v_sub_f32 v31, v20, v29
v_fmac_f32 v30, v31, v31
v_sub_f32 v31, v21, v29
v_fmac_f32 v30, v31, v31
v_sub_f32 v31, v22, v29
v_fmac_f32 v30, v31, v31
v_sub_f32 v31, v23, v29
v_fmac_f32 v30, v31, v31
v_sub_f32 v31, v24, v29
v_fmac_f32 v30, v31, v31
v_sub_f32 v31, v25, v29
v_fmac_f32 v30, v31, v31
v_sub_f32 v31, v26, v29
v_fmac_f32 v30, v31, v31
v_sub_f32 v31, v27, v29
v_fmac_f32 v30, v31, v31
v_cmp_gt_u32 vcc, 56, v0
s_nop 1
v_cndmask_b32 v30, 0, v30, vcc
s_nop 1
v_add_f32_dpp v30, v30, v30 quad_perm:[1,0,3,2] row_mask:0xf bank_mask:0xf
s_nop 1
v_add_f32_dpp v30, v30, v30 quad_perm:[2,3,0,1] row_mask:0xf bank_mask:0xf
s_nop 1
v_add_f32_dpp v30, v30, v30 row_ror:4 row_mask:0xf bank_mask:0xf
s_nop 1
v_add_f32_dpp v30, v30, v30 row_ror:8 row_mask:0xf bank_mask:0xf
v_mov_b32 v31, v30
s_nop 1
v_permlane16_swap_b32 v30, v31
s_nop 0
v_add_f32 v30, v30, v31
v_mov_b32 v31, v30
s_nop 1
v_permlane32_swap_b32 v30, v31
s_nop 0
v_add_f32 v30, v30, v31
v_mul_f32 v31, s60, v30
v_fma_f32 v32, -v31, s61, v30
v_fma_f32 v31, v32, s60, v31
v_cvt_pk_bf16_f32 v29, v29, v29
v_lshlrev_b32 v29, 16, v29
v_cvt_pk_bf16_f32 v31, v31, v31
v_lshlrev_b32 v31, 16, v31
v_add_f32 v31, 0x3727c5ac, v31
v_cvt_pk_bf16_f32 v31, v31, v31
v_lshlrev_b32 v31, 16, v31
v_sqrt_f32 v31, v31
s_nop 0
v_cvt_pk_bf16_f32 v31, v31, v31
v_lshlrev_b32 v31, 16, v31
v_rcp_f32 v32, v31
s_nop 0
v_sub_f32 v20, v20, v29
v_sub_f32 v21, v21, v29
v_cvt_pk_bf16_f32 v33, v20, v21
v_lshlrev_b32 v20, 16, v33
v_and_b32 v21, 0xffff0000, v33
v_mul_f32 v34, v20, v32
v_fma_f32 v35, -v34, v31, v20
v_fma_f32 v20, v35, v32, v34
v_mul_f32 v34, v21, v32
v_fma_f32 v35, -v34, v31, v21
v_fma_f32 v21, v35, v32, v34
v_cvt_pk_bf16_f32 v16, v20, v21
v_sub_f32 v22, v22, v29
v_sub_f32 v23, v23, v29
v_cvt_pk_bf16_f32 v33, v22, v23
v_lshlrev_b32 v22, 16, v33
v_and_b32 v23, 0xffff0000, v33
v_mul_f32 v34, v22, v32
v_fma_f32 v35, -v34, v31, v22
v_fma_f32 v22, v35, v32, v34
v_mul_f32 v34, v23, v32
v_fma_f32 v35, -v34, v31, v23
v_fma_f32 v23, v35, v32, v34
v_cvt_pk_bf16_f32 v17, v22, v23
v_sub_f32 v24, v24, v29
v_sub_f32 v25, v25, v29
v_cvt_pk_bf16_f32 v33, v24, v25
v_lshlrev_b32 v24, 16, v33
v_and_b32 v25, 0xffff0000, v33
v_mul_f32 v34, v24, v32
v_fma_f32 v35, -v34, v31, v24
v_fma_f32 v24, v35, v32, v34
v_mul_f32 v34, v25, v32
v_fma_f32 v35, -v34, v31, v25
v_fma_f32 v25, v35, v32, v34
v_cvt_pk_bf16_f32 v18, v24, v25
v_sub_f32 v26, v26, v29
v_sub_f32 v27, v27, v29
v_cvt_pk_bf16_f32 v33, v26, v27
v_lshlrev_b32 v26, 16, v33
v_and_b32 v27, 0xffff0000, v33
v_mul_f32 v34, v26, v32
v_fma_f32 v35, -v34, v31, v26
v_fma_f32 v26, v35, v32, v34
v_mul_f32 v34, v27, v32
v_fma_f32 v35, -v34, v31, v27
v_fma_f32 v27, v35, v32, v34
v_cvt_pk_bf16_f32 v19, v26, v27
v_lshlrev_b32 v4, 4, v0
v_add_u32 v4, 155648, v4
ds_write_b128 v4, v[16:19]
v_add_u32 v6, s46, v2
v_lshlrev_b32 v6, 1, v6
v_add_u32 v6, 155648, v6
s_waitcnt lgkmcnt(0)
ds_read_u16 v40, v6 offset:0
ds_read_u16 v41, v6 offset:16
ds_read_u16 v42, v6 offset:32
ds_read_u16 v43, v6 offset:48
ds_read_u16 v44, v6 offset:64
ds_read_u16 v45, v6 offset:80
ds_read_u16 v46, v6 offset:96
ds_read_u16 v47, v6 offset:112
ds_read_u16 v48, v6 offset:128
ds_read_u16 v49, v6 offset:144
ds_read_u16 v50, v6 offset:160
ds_read_u16 v51, v6 offset:176
ds_read_u16 v52, v6 offset:192
ds_read_u16 v53, v6 offset:208
v_mov_b32 v32, 0
v_mov_b32 v33, 0
v_mov_b32 v34, 0
v_mov_b32 v35, 0
v_mov_b32 v36, 0
v_mov_b32 v37, 0
v_mov_b32 v38, 0
v_mov_b32 v39, 0
s_waitcnt vmcnt(0) lgkmcnt(0)
v_lshlrev_b32 v54, 16, v40
v_dot2_f32_bf16 v32, v64, v40, v32
v_dot2_f32_bf16 v34, v65, v40, v34
v_dot2_f32_bf16 v36, v66, v40, v36
v_dot2_f32_bf16 v38, v67, v40, v38
v_dot2_f32_bf16 v33, v64, v54, v33
v_dot2_f32_bf16 v35, v65, v54, v35
v_dot2_f32_bf16 v37, v66, v54, v37
v_dot2_f32_bf16 v39, v67, v54, v39
v_lshlrev_b32 v55, 16, v41
v_dot2_f32_bf16 v32, v68, v41, v32
v_dot2_f32_bf16 v34, v69, v41, v34
v_dot2_f32_bf16 v36, v70, v41, v36
v_dot2_f32_bf16 v38, v71, v41, v38
v_dot2_f32_bf16 v33, v68, v55, v33
v_dot2_f32_bf16 v35, v69, v55, v35
v_dot2_f32_bf16 v37, v70, v55, v37
v_dot2_f32_bf16 v39, v71, v55, v39
v_lshlrev_b32 v54, 16, v42
v_dot2_f32_bf16 v32, v72, v42, v32
v_dot2_f32_bf16 v34, v73, v42, v34
v_dot2_f32_bf16 v36, v74, v42, v36
v_dot2_f32_bf16 v38, v75, v42, v38
v_dot2_f32_bf16 v33, v72, v54, v33
v_dot2_f32_bf16 v35, v73, v54, v35
v_dot2_f32_bf16 v37, v74, v54, v37
v_dot2_f32_bf16 v39, v75, v54, v39
v_lshlrev_b32 v55, 16, v43
v_dot2_f32_bf16 v32, v76, v43, v32
v_dot2_f32_bf16 v34, v77, v43, v34
v_dot2_f32_bf16 v36, v78, v43, v36
v_dot2_f32_bf16 v38, v79, v43, v38
v_dot2_f32_bf16 v33, v76, v55, v33
v_dot2_f32_bf16 v35, v77, v55, v35
v_dot2_f32_bf16 v37, v78, v55, v37
v_dot2_f32_bf16 v39, v79, v55, v39
v_lshlrev_b32 v54, 16, v44
v_dot2_f32_bf16 v32, v80, v44, v32
v_dot2_f32_bf16 v34, v81, v44, v34
v_dot2_f32_bf16 v36, v82, v44, v36
v_dot2_f32_bf16 v38, v83, v44, v38
v_dot2_f32_bf16 v33, v80, v54, v33
v_dot2_f32_bf16 v35, v81, v54, v35
v_dot2_f32_bf16 v37, v82, v54, v37
v_dot2_f32_bf16 v39, v83, v54, v39
v_lshlrev_b32 v55, 16, v45
v_dot2_f32_bf16 v32, v84, v45, v32
v_dot2_f32_bf16 v34, v85, v45, v34
v_dot2_f32_bf16 v36, v86, v45, v36
v_dot2_f32_bf16 v38, v87, v45, v38
v_dot2_f32_bf16 v33, v84, v55, v33
v_dot2_f32_bf16 v35, v85, v55, v35
v_dot2_f32_bf16 v37, v86, v55, v37
v_dot2_f32_bf16 v39, v87, v55, v39
v_lshlrev_b32 v54, 16, v46
v_dot2_f32_bf16 v32, v88, v46, v32
v_dot2_f32_bf16 v34, v89, v46, v34
v_dot2_f32_bf16 v36, v90, v46, v36
v_dot2_f32_bf16 v38, v91, v46, v38
v_dot2_f32_bf16 v33, v88, v54, v33
v_dot2_f32_bf16 v35, v89, v54, v35
v_dot2_f32_bf16 v37, v90, v54, v37
v_dot2_f32_bf16 v39, v91, v54, v39
s_cmp_eq_u32 s30, 5
s_cbranch_scc1 L_gemv_red
v_lshlrev_b32 v55, 16, v47
v_dot2_f32_bf16 v32, v92, v47, v32
v_dot2_f32_bf16 v34, v93, v47, v34
v_dot2_f32_bf16 v36, v94, v47, v36
v_dot2_f32_bf16 v38, v95, v47, v38
v_dot2_f32_bf16 v33, v92, v55, v33
v_dot2_f32_bf16 v35, v93, v55, v35
v_dot2_f32_bf16 v37, v94, v55, v37
v_dot2_f32_bf16 v39, v95, v55, v39
v_lshlrev_b32 v54, 16, v48
v_dot2_f32_bf16 v32, v96, v48, v32
v_dot2_f32_bf16 v34, v97, v48, v34
v_dot2_f32_bf16 v36, v98, v48, v36
v_dot2_f32_bf16 v38, v99, v48, v38
v_dot2_f32_bf16 v33, v96, v54, v33
v_dot2_f32_bf16 v35, v97, v54, v35
v_dot2_f32_bf16 v37, v98, v54, v37
v_dot2_f32_bf16 v39, v99, v54, v39
v_lshlrev_b32 v55, 16, v49
v_dot2_f32_bf16 v32, v100, v49, v32
v_dot2_f32_bf16 v34, v101, v49, v34
v_dot2_f32_bf16 v36, v102, v49, v36
v_dot2_f32_bf16 v38, v103, v49, v38
v_dot2_f32_bf16 v33, v100, v55, v33
v_dot2_f32_bf16 v35, v101, v55, v35
v_dot2_f32_bf16 v37, v102, v55, v37
v_dot2_f32_bf16 v39, v103, v55, v39
v_lshlrev_b32 v54, 16, v50
v_dot2_f32_bf16 v32, v104, v50, v32
v_dot2_f32_bf16 v34, v105, v50, v34
v_dot2_f32_bf16 v36, v106, v50, v36
v_dot2_f32_bf16 v38, v107, v50, v38
v_dot2_f32_bf16 v33, v104, v54, v33
v_dot2_f32_bf16 v35, v105, v54, v35
v_dot2_f32_bf16 v37, v106, v54, v37
v_dot2_f32_bf16 v39, v107, v54, v39
v_lshlrev_b32 v55, 16, v51
v_dot2_f32_bf16 v32, v108, v51, v32
v_dot2_f32_bf16 v34, v109, v51, v34
v_dot2_f32_bf16 v36, v110, v51, v36
v_dot2_f32_bf16 v38, v111, v51, v38
v_dot2_f32_bf16 v33, v108, v55, v33
v_dot2_f32_bf16 v35, v109, v55, v35
v_dot2_f32_bf16 v37, v110, v55, v37
v_dot2_f32_bf16 v39, v111, v55, v39
v_lshlrev_b32 v54, 16, v52
v_dot2_f32_bf16 v32, v112, v52, v32
v_dot2_f32_bf16 v34, v113, v52, v34
v_dot2_f32_bf16 v36, v114, v52, v36
v_dot2_f32_bf16 v38, v115, v52, v38
v_dot2_f32_bf16 v33, v112, v54, v33
v_dot2_f32_bf16 v35, v113, v54, v35
v_dot2_f32_bf16 v37, v114, v54, v37
v_dot2_f32_bf16 v39, v115, v54, v39
v_lshlrev_b32 v55, 16, v53
v_dot2_f32_bf16 v32, v116, v53, v32
v_dot2_f32_bf16 v34, v117, v53, v34
v_dot2_f32_bf16 v36, v118, v53, v36
v_dot2_f32_bf16 v38, v119, v53, v38
v_dot2_f32_bf16 v33, v116, v55, v33
v_dot2_f32_bf16 v35, v117, v55, v35
v_dot2_f32_bf16 v37, v118, v55, v37
v_dot2_f32_bf16 v39, v119, v55, v39
L_gemv_red:
s_nop 3
s_nop 1
v_permlane32_swap_b32 v32, v36
v_permlane32_swap_b32 v33, v37
v_permlane32_swap_b32 v34, v38
v_permlane32_swap_b32 v35, v39
s_nop 0
v_add_f32 v32, v32, v36
v_add_f32 v33, v33, v37
v_add_f32 v34, v34, v38
v_add_f32 v35, v35, v39
s_nop 1
v_permlane16_swap_b32 v32, v34
v_permlane16_swap_b32 v33, v35
s_nop 0
v_add_f32 v32, v32, v34
v_add_f32 v33, v33, v35
v_and_b32 v42, 8, v0
v_cmp_ne_u32 vcc, 0, v42
v_add_f32_dpp v32, v32, v32 row_ror:8 row_mask:0xf bank_mask:0xf
v_add_f32_dpp v33, v33, v33 row_ror:8 row_mask:0xf bank_mask:0xf
s_nop 0
v_cndmask_b32 v32, v32, v33, vcc
v_readfirstlane_b32 s33, v63
s_add_u32 s33, s33, 2654435769
v_mov_b32 v33, s33
v_lshlrev_b32 v34, 6, v3
v_lshl_add_u32 v34, v2, 3, v34
s_cmp_eq_u32 s30, 5
s_cbranch_scc1 L_f_pub
v_mov_b32 v36, v32
v_mov_b32 v38, v32
s_nop 0
v_mov_b32_dpp v35, v32 row_ror:8 row_mask:0xf bank_mask:0xf
v_permlane16_swap_b32 v38, v36
s_nop 1
v_mov_b32_dpp v37, v36 row_ror:8 row_mask:0xf bank_mask:0xf
s_mov_b32 s60, 0x05030201
s_mov_b32 s61, 0x06050302
s_mov_b32 s62, 0x07060503
v_add_u32 v32, 0x80, v32
v_add_u32 v35, 0x80, v35
v_add_u32 v36, 0x80, v36
v_add_u32 v37, 0x80, v37
v_perm_b32 v100, v35, v32, s60
v_perm_b32 v101, v36, v35, s61
v_perm_b32 v102, v37, v36, s62
v_add_u32 v103, s34, v33
v_lshrrev_b32 v34, 5, v0
v_lshl_add_u32 v34, v3, 1, v34
v_lshlrev_b32 v34, 4, v34
s_lshl_b32 s60, s31, 13
s_lshl_b32 s61, s32, 8
s_add_u32 s60, s60, s61
s_add_u32 s60, s60, 65536
v_add_u32 v34, s60, v34
s_mov_b32 exec_lo, 0xff
s_mov_b32 exec_hi, 0xff
global_store_dwordx4 v34, v[100:103], s[28:29]
s_mov_b64 exec, -1
v_add_u32 v104, 0x1000000, v34
s_branch L_common2
L_f_pub:
s_cmp_eq_u32 s31, 7
s_cbranch_scc1 L_g_zero
s_lshl_b32 s60, s64, 9
s_add_u32 s60, s60, 262144
v_add_u32 v34, s60, v34
global_store_dwordx2 v34, v[32:33], s[28:29]
v_add_u32 v34, 0x1000000, v34
global_store_dwordx2 v34, v[32:33], s[28:29] sc1
v_lshrrev_b32 v4, 2, v0
v_and_b32 v4, 7, v4
v_lshlrev_b32 v4, 9, v4
v_and_b32 v5, 3, v0
v_lshl_add_u32 v4, v5, 4, v4
s_lshl_b32 s60, s31, 5
s_and_b32 s61, s32, 24
s_add_u32 s60, s60, s61
s_lshl_b32 s60, s60, 9
s_and_b32 s61, s32, 7
s_lshl_b32 s61, s61, 6
s_add_u32 s60, s60, s61
s_add_u32 s60, s60, 262144
v_add_u32 v4, s60, v4
s_sleep 24
s_mov_b32 s68, 0
L_pl_1:
global_load_dwordx4 v[64:67], v4, s[28:29] sc1
s_waitcnt vmcnt(0)
L_pc_2:
v_cmp_ne_u32 vcc, s33, v65
s_mov_b64 s[62:63], vcc
v_cmp_ne_u32 vcc, s33, v67
s_or_b64 s[62:63], s[62:63], vcc
s_and_b64 exec, s[62:63], s[62:63]
s_cbranch_scc0 L_pd_3
s_sleep 8
s_add_u32 s68, s68, 1
s_cmp_lt_u32 s68, 2
s_cbranch_scc1 L_pn_4
v_xor_b32 v4, 0x1000000, v4
L_pn_4:
s_add_u32 s59, s59, 1
s_bitcmp1_b32 s59, 22
s_cbranch_scc0 L_pl_1
s_branch L_end
L_pd_3:
s_mov_b64 exec, -1
s_nop 1
v_add_f32_dpp v64, v64, v64 row_ror:4 row_mask:0xf bank_mask:0xf
s_nop 1
v_add_f32_dpp v64, v64, v64 row_ror:8 row_mask:0xf bank_mask:0xf
v_mov_b32 v68, v64
s_nop 1
v_permlane16_swap_b32 v64, v68
s_nop 0
v_add_f32 v64, v64, v68
s_nop 1
v_add_f32_dpp v66, v66, v66 row_ror:4 row_mask:0xf bank_mask:0xf
s_nop 1
v_add_f32_dpp v66, v66, v66 row_ror:8 row_mask:0xf bank_mask:0xf
v_mov_b32 v68, v66
s_nop 1
v_permlane16_swap_b32 v66, v68
s_nop 0
v_add_f32 v66, v66, v68
v_cvt_pk_bf16_f32 v64, v64, v66
v_lshlrev_b32 v65, 16, v64
v_and_b32 v66, 0xffff0000, v64
v_lshlrev_b32 v67, 16, v60
v_and_b32 v68, 0xffff0000, v60
v_add_f32 v65, v65, v67
v_add_f32 v66, v66, v68
v_cvt_pk_bf16_f32 v64, v65, v66
v_lshlrev_b32 v65, 16, v64
v_and_b32 v66, 0xffff0000, v64
s_mov_b32 s60, 0x40135761
s_mov_b32 s61, 0x3d372713
v_mul_f32 v67, v65, v65
v_mul_f32 v67, v67, v65
v_fma_f32 v67, v67, s61, v65
v_mul_f32 v67, s60, v67
v_exp_f32 v67, v67
s_nop 0
v_add_f32 v67, 1.0, v67
v_rcp_f32 v67, v67
s_nop 0
v_sub_f32 v67, 1.0, v67
v_mul_f32 v65, v65, v67
v_mul_f32 v67, v66, v66
v_mul_f32 v67, v67, v66
v_fma_f32 v67, v67, s61, v66
v_mul_f32 v67, s60, v67
v_exp_f32 v67, v67
s_nop 0
v_add_f32 v67, 1.0, v67
v_rcp_f32 v67, v67
s_nop 0
v_sub_f32 v67, 1.0, v67
v_mul_f32 v66, v66, v67
v_cvt_pk_bf16_f32 v64, v65, v66
s_branch L_g_wr
L_g_zero:
v_mov_b32 v64, 0
L_g_wr:
v_and_b32 v4, 3, v0
v_lshlrev_b32 v4, 2, v4
v_add_u32 v4, 158784, v4
ds_write_b32 v4, v64
s_waitcnt lgkmcnt(0)
v_mov_b32 v14, 1
ds_write_b32 v15, v14 offset:20
L_wl_5:
ds_read_b32 v14, v15 offset:12
s_waitcnt lgkmcnt(0)
v_readfirstlane_b32 s58, v14
s_cmp_ge_u32 s58, 4
s_cbranch_scc1 L_wld_6
s_sleep 6
s_add_u32 s59, s59, 1
s_bitcmp1_b32 s59, 22
s_cbranch_scc0 L_wl_5
s_branch L_end
L_wld_6:
ds_read_b32 v14, v15 offset:40
s_waitcnt lgkmcnt(0)
v_readfirstlane_b32 s35, v14
s_cmp_eq_u32 s35, 4
s_cselect_b32 s36, 0, 0x1000000
v_and_b32 v4, 31, v0
v_lshlrev_b32 v4, 4, v4
s_lshl_b32 s60, s31, 1
s_lshr_b32 s61, s32, 4
s_add_u32 s60, s60, s61
s_lshl_b32 s60, s60, 9
s_add_u32 s60, s60, 458752
s_add_u32 s60, s60, s36
v_add_u32 v24, s60, v4
v_and_b32 v26, 31, v0
v_lshlrev_b32 v26, 2, v26
v_add_u32 v26, 158912, v26
s_mov_b32 s65, 0x3db8aa3b
L_wl_7:
ds_read_b32 v14, v15 offset:0
s_waitcnt lgkmcnt(0)
v_readfirstlane_b32 s58, v14
s_cmp_ge_u32 s58, 1
s_cbranch_scc1 L_wld_8
s_sleep 4
s_add_u32 s59, s59, 1
s_bitcmp1_b32 s59, 22
s_cbranch_scc0 L_wl_7
s_branch L_end
L_wld_8:
v_lshlrev_b32 v4, 7, v0
s_lshl_b32 s60, s64, 11
s_add_u32 s60, s60, 1048576
v_add_u32 v4, s60, v4
s_mov_b64 exec, 0xffff
global_load_dword v8, v4, s[28:29]
s_mov_b32 exec_lo, -1
global_load_dwordx4 v[80:83], v24, s[28:29] sc1
s_mov_b64 exec, -1
L_wl_9:
ds_read_b32 v14, v15 offset:36
s_waitcnt lgkmcnt(0)
v_readfirstlane_b32 s58, v14
s_cmp_ge_u32 s58, 1
s_cbranch_scc1 L_wld_10
s_sleep 4
s_add_u32 s59, s59, 1
s_bitcmp1_b32 s59, 22
s_cbranch_scc0 L_wl_9
s_branch L_end
L_wld_10:
s_sleep 6
s_mov_b32 s68, 0
L_pl_11:
global_load_dwordx4 v[80:83], v24, s[28:29] sc1
s_waitcnt vmcnt(0)
L_pc_12:
v_cmp_ne_u32 vcc, s33, v81
s_mov_b64 s[62:63], vcc
v_cmp_ne_u32 vcc, s33, v83
s_or_b64 s[62:63], s[62:63], vcc
s_and_b64 exec, s[62:63], s[62:63]
s_cbranch_scc0 L_pd_13
s_sleep 4
s_add_u32 s68, s68, 1
s_cmp_lt_u32 s68, 6
s_cbranch_scc1 L_pn_14
v_xor_b32 v24, 0x1000000, v24
L_pn_14:
s_add_u32 s59, s59, 1
s_bitcmp1_b32 s59, 22
s_cbranch_scc0 L_pl_11
s_branch L_end
L_pd_13:
s_mov_b64 exec, -1
v_mov_b32 v84, v80
s_nop 1
v_max_f32_dpp v84, v84, v84 quad_perm:[1,0,3,2] row_mask:0xf bank_mask:0xf
s_nop 1
v_max_f32_dpp v84, v84, v84 quad_perm:[2,3,0,1] row_mask:0xf bank_mask:0xf
s_nop 1
v_max_f32_dpp v84, v84, v84 row_ror:4 row_mask:0xf bank_mask:0xf
s_nop 1
v_max_f32_dpp v84, v84, v84 row_ror:8 row_mask:0xf bank_mask:0xf
v_mov_b32 v85, v84
s_nop 1
v_permlane16_swap_b32 v84, v85
s_nop 0
v_max_f32 v84, v84, v85
v_sub_f32 v84, v80, v84
v_mul_f32 v84, s65, v84
v_exp_f32 v84, v84
s_nop 0
v_mul_f32 v85, v84, v82
s_nop 1
v_add_f32_dpp v85, v85, v85 quad_perm:[1,0,3,2] row_mask:0xf bank_mask:0xf
s_nop 1
v_add_f32_dpp v85, v85, v85 quad_perm:[2,3,0,1] row_mask:0xf bank_mask:0xf
s_nop 1
v_add_f32_dpp v85, v85, v85 row_ror:4 row_mask:0xf bank_mask:0xf
s_nop 1
v_add_f32_dpp v85, v85, v85 row_ror:8 row_mask:0xf bank_mask:0xf
v_mov_b32 v86, v85
s_nop 1
v_permlane16_swap_b32 v85, v86
s_nop 0
v_add_f32 v85, v85, v86
v_rcp_f32 v85, v85
s_nop 0
v_mul_f32 v84, v84, v85
ds_write_b32 v26, v84
v_mov_b32 v14, 1
ds_write_b32 v15, v14 offset:44
s_waitcnt lgkmcnt(0)
s_endpgm
L_common:
s_waitcnt vmcnt(0)
v_readfirstlane_b32 s33, v63
s_add_u32 s33, s33, 2654435769
L_common2:
v_and_b32 v6, 15, v0
v_lshrrev_b32 v5, 4, v0
v_xor_b32 v7, v5, v6
s_lshl_b32 s60, s30, 14
v_xor_b32 v8, 0, v7
v_lshlrev_b32 v8, 4, v8
v_lshl_add_u32 v8, v6, 9, v8
v_add_u32 v8, s60, v8
v_xor_b32 v9, 4, v7
v_lshlrev_b32 v9, 4, v9
v_lshl_add_u32 v9, v6, 9, v9
v_add_u32 v9, s60, v9
v_xor_b32 v10, 8, v7
v_lshlrev_b32 v10, 4, v10
v_lshl_add_u32 v10, v6, 9, v10
v_add_u32 v10, s60, v10
v_xor_b32 v11, 12, v7
v_lshlrev_b32 v11, 4, v11
v_lshl_add_u32 v11, v6, 9, v11
v_add_u32 v11, s60, v11
v_and_b32 v4, 1, v0
v_lshlrev_b32 v4, 9, v4
v_lshl_add_u32 v4, v5, 4, v4
v_add_u32 v27, 156672, v4
v_and_b32 v4, 1, v0
v_lshl_add_u32 v4, v5, 1, v4
v_lshlrev_b32 v4, 4, v4
v_add_u32 v4, 157696, v4
s_lshl_b32 s60, s30, 7
v_add_u32 v30, s60, v4
v_mov_b32 v7, 158208
s_mov_b32 s66, 0x30003
s_mov_b32 s67, s66
v_cndmask_b32 v20, v7, v4, s[66:67]
s_mov_b32 s66, 0xc000c
s_mov_b32 s67, s66
v_cndmask_b32 v21, v7, v4, s[66:67]
s_mov_b32 s66, 0x300030
s_mov_b32 s67, s66
v_cndmask_b32 v22, v7, v4, s[66:67]
s_mov_b32 s66, 0xc000c0
s_mov_b32 s67, s66
v_cndmask_b32 v23, v7, v4, s[66:67]
v_and_b32 v31, 1, v0
v_lshlrev_b32 v31, 3, v31
v_add_u32 v31, 158720, v31
v_lshrrev_b32 v4, 2, v0
v_and_b32 v7, 7, v4
v_and_b32 v12, 3, v0
v_lshlrev_b32 v12, 3, v12
v_lshl_add_u32 v12, v4, 9, v12
v_add_u32 v12, 65536, v12
s_lshl_b32 s60, s30, 2
s_add_u32 s61, s60, 0
v_xor_b32 v16, s61, v7
v_lshl_add_u32 v16, v16, 5, v12
s_add_u32 s61, s60, 1
v_xor_b32 v17, s61, v7
v_lshl_add_u32 v17, v17, 5, v12
s_add_u32 s61, s60, 2
v_xor_b32 v18, s61, v7
v_lshl_add_u32 v18, v18, 5, v12
s_add_u32 s61, s60, 3
v_xor_b32 v19, s61, v7
v_lshl_add_u32 v19, v19, 5, v12
s_lshl_b32 s66, s64, 11
s_add_u32 s66, s66, 1048576
v_and_b32 v4, 1, v0
v_lshlrev_b32 v4, 4, v4
v_bfe_u32 v7, v0, 1, 3
v_add3_u32 v4, v4, v7, s60
v_lshlrev_b32 v4, 6, v4
v_lshl_add_u32 v4, v5, 4, v4
v_add_u32 v12, s66, v4
v_add_u32 v13, 0x1000000, v12
v_mov_b32 v243, s33
s_lshl_b32 s60, s31, 13
s_lshl_b32 s61, s30, 11
s_add_u32 s60, s60, s61
s_add_u32 s60, s60, 65536
v_lshlrev_b32 v25, 4, v0
v_add_u32 v25, s60, v25
v_lshrrev_b32 v4, 5, v0
v_lshlrev_b32 v26, 7, v4
v_and_b32 v7, 15, v0
v_lshl_add_u32 v26, v7, 3, v26
v_bfe_u32 v7, v0, 4, 1
v_lshl_add_u32 v26, v7, 2, v26
s_lshl_b32 s60, s30, 8
s_add_u32 s60, s60, 156672
v_add_u32 v26, s60, v26
s_mul_i32 s60, s30, 56
v_add_u32 v4, s60, v0
v_lshrrev_b32 v29, 2, v4
v_lshlrev_b32 v29, 13, v29
v_bfe_u32 v7, v4, 1, 1
v_lshl_add_u32 v29, v7, 4, v29
s_lshl_b32 s60, s2, 5
s_add_u32 s60, s60, 3145728
v_add_u32 v29, s60, v29
v_lshlrev_b32 v4, 2, v4
v_add_u32 v28, 131072, v4
s_lshl_b32 s60, s53, 13
s_lshl_b32 s61, s30, 11
s_add_u32 s60, s60, s61
s_add_u32 s60, s60, 3145728
v_lshlrev_b32 v248, 4, v0
v_add_u32 v248, s60, v248
v_add_u32 v249, 1024, v248
v_and_b32 v7, 1, v0
v_lshrrev_b32 v4, 5, v0
v_lshlrev_b32 v4, 1, v4
v_lshl_add_u32 v4, v7, 2, v4
v_bfe_u32 v7, v0, 4, 1
v_add_u32 v4, v4, v7
v_lshlrev_b32 v252, 2, v4
v_add_u32 v252, 155648, v252
s_lshl_b32 s60, s30, 5
v_add_u32 v253, s60, v252
s_lshl_b32 s60, s53, 3
v_add_u32 v4, s60, v4
v_lshlrev_b32 v24, 1, v4
s_mov_b32 s65, 0x3db8aa3b
s_cmp_lg_u32 s30, 0
s_cbranch_scc1 L_wait_pub
global_load_ushort v254, v24, s[4:5]
global_load_ushort v255, v24, s[22:23]
s_sleep 16
v_mov_b32 v14, 1
ds_write_b32 v15, v14 offset:16
s_branch L_qgather
L_wait_pub:
L_wl_15:
ds_read_b32 v14, v15 offset:16
s_waitcnt lgkmcnt(0)
v_readfirstlane_b32 s58, v14
s_cmp_ge_u32 s58, 1
s_cbranch_scc1 L_wld_16
s_sleep 4
s_add_u32 s59, s59, 1
s_bitcmp1_b32 s59, 22
s_cbranch_scc0 L_wl_15
s_branch L_end
L_wld_16:
L_qgather:
s_mov_b32 s68, 0
global_load_dwordx4 v[64:67], v25, s[28:29] sc1
global_load_dwordx4 v[68:71], v25, s[28:29] offset:1024 sc1
s_cmp_lg_u32 s30, 0
s_cbranch_scc1 L_qs_21
s_mov_b32 exec_lo, 0xff
s_mov_b32 exec_hi, 0xff
global_store_dwordx4 v104, v[100:103], s[28:29] sc1
s_mov_b64 exec, -1
s_branch L_qr_22
L_qs_21:
s_waitcnt vmcnt(0)
L_qr_22:
s_waitcnt vmcnt(1)
s_branch L_pc_18
L_pl_17:
global_load_dwordx4 v[64:67], v25, s[28:29] sc1
global_load_dwordx4 v[68:71], v25, s[28:29] offset:1024 sc1
s_waitcnt vmcnt(0)
L_pc_18:
v_subrev_u32 v67, s33, v67
v_cmp_le_u32 vcc, 16, v67
s_mov_b64 s[62:63], vcc
v_subrev_u32 v71, s33, v71
v_cmp_le_u32 vcc, 16, v71
s_or_b64 s[62:63], s[62:63], vcc
s_and_b64 exec, s[62:63], s[62:63]
s_cbranch_scc0 L_pd_19
s_sleep 8
s_add_u32 s68, s68, 1
s_cmp_lt_u32 s68, 2
s_cbranch_scc1 L_pn_20
v_xor_b32 v25, 0x1000000, v25
L_pn_20:
s_add_u32 s59, s59, 1
s_bitcmp1_b32 s59, 22
s_cbranch_scc0 L_pl_17
s_branch L_end
L_pd_19:
s_mov_b64 exec, -1
s_mov_b32 s60, 0x0504030c
s_mov_b32 s61, 0x0403020c
v_lshlrev_b32 v72, 8, v64
v_perm_b32 v73, v65, v64, s60
v_perm_b32 v74, v66, v65, s61
v_and_b32 v75, 0xffffff00, v66
v_lshlrev_b32 v76, 8, v68
v_perm_b32 v77, v69, v68, s60
v_perm_b32 v78, v70, v69, s61
v_and_b32 v79, 0xffffff00, v70
s_nop 0
v_permlane32_swap_b32 v72, v76
v_permlane32_swap_b32 v73, v77
v_permlane32_swap_b32 v74, v78
v_permlane32_swap_b32 v75, v79
s_nop 0
v_add_f32 v72, v72, v76
v_add_f32 v73, v73, v77
v_add_f32 v74, v74, v78
v_add_f32 v75, v75, v79
s_nop 1
v_permlane16_swap_b32 v72, v74
v_permlane16_swap_b32 v73, v75
s_nop 0
v_add_f32 v72, v72, v74
v_add_f32 v73, v73, v75
v_cvt_pk_bf16_f32 v64, v72, v73
ds_write_b32 v26, v64
v_cmp_ne_u32 vcc, s34, v67
s_mov_b64 s[62:63], vcc
v_cmp_ne_u32 vcc, s34, v71
s_or_b64 s[62:63], s[62:63], vcc
s_cmp_lg_u64 s[62:63], 0
s_cbranch_scc1 L_nl_23
s_mov_b64 exec, 1
v_mov_b32 v14, 1
ds_add_u32 v15, v14 offset:40
s_mov_b64 exec, -1
L_nl_23:
s_waitcnt lgkmcnt(0)
s_mov_b64 exec, 1
v_mov_b32 v14, 1
ds_add_u32 v15, v14 offset:12
s_mov_b64 exec, -1
L_wl_24:
ds_read_b32 v14, v15 offset:0
s_waitcnt lgkmcnt(0)
v_readfirstlane_b32 s58, v14
s_cmp_ge_u32 s58, 1
s_cbranch_scc1 L_wld_25
s_sleep 3
s_add_u32 s59, s59, 1
s_bitcmp1_b32 s59, 22
s_cbranch_scc0 L_wl_24
s_branch L_end
L_wld_25:
ds_read_b128 v[64:67], v8 offset:0
ds_read_b128 v[68:71], v9 offset:0
ds_read_b128 v[72:75], v10 offset:0
ds_read_b128 v[76:79], v11 offset:0
ds_read_b128 v[80:83], v8 offset:256
ds_read_b128 v[84:87], v9 offset:256
ds_read_b128 v[88:91], v10 offset:256
ds_read_b128 v[92:95], v11 offset:256
ds_read_b128 v[96:99], v8 offset:8192
ds_read_b128 v[100:103], v9 offset:8192
ds_read_b128 v[104:107], v10 offset:8192
ds_read_b128 v[108:111], v11 offset:8192
ds_read_b128 v[112:115], v8 offset:8448
ds_read_b128 v[116:119], v9 offset:8448
ds_read_b128 v[120:123], v10 offset:8448
ds_read_b128 v[124:127], v11 offset:8448
L_wl_26:
ds_read_b32 v14, v15 offset:12
s_waitcnt lgkmcnt(0)
v_readfirstlane_b32 s58, v14
s_cmp_ge_u32 s58, 4
s_cbranch_scc1 L_wld_27
s_sleep 1
s_add_u32 s59, s59, 1
s_bitcmp1_b32 s59, 22
s_cbranch_scc0 L_wl_26
s_branch L_end
L_wld_27:
ds_read_b32 v14, v15 offset:40
s_waitcnt lgkmcnt(0)
v_readfirstlane_b32 s35, v14
ds_read_b128 v[32:35], v27 offset:0
ds_read_b128 v[36:39], v27 offset:64
ds_read_b128 v[40:43], v27 offset:128
ds_read_b128 v[44:47], v27 offset:192
ds_read_b128 v[48:51], v27 offset:256
ds_read_b128 v[52:55], v27 offset:320
ds_read_b128 v[56:59], v27 offset:384
ds_read_b128 v[60:63], v27 offset:448
s_waitcnt lgkmcnt(7)
v_mfma_f32_16x16x32_bf16 v[128:131], v[64:67], v[32:35], 0
v_mfma_f32_16x16x32_bf16 v[132:135], v[96:99], v[32:35], 0
s_waitcnt lgkmcnt(6)
v_mfma_f32_16x16x32_bf16 v[128:131], v[68:71], v[36:39], v[128:131]
v_mfma_f32_16x16x32_bf16 v[132:135], v[100:103], v[36:39], v[132:135]
s_waitcnt lgkmcnt(5)
v_mfma_f32_16x16x32_bf16 v[128:131], v[72:75], v[40:43], v[128:131]
v_mfma_f32_16x16x32_bf16 v[132:135], v[104:107], v[40:43], v[132:135]
s_waitcnt lgkmcnt(4)
v_mfma_f32_16x16x32_bf16 v[128:131], v[76:79], v[44:47], v[128:131]
v_mfma_f32_16x16x32_bf16 v[132:135], v[108:111], v[44:47], v[132:135]
s_waitcnt lgkmcnt(3)
v_mfma_f32_16x16x32_bf16 v[128:131], v[80:83], v[48:51], v[128:131]
v_mfma_f32_16x16x32_bf16 v[132:135], v[112:115], v[48:51], v[132:135]
s_waitcnt lgkmcnt(2)
v_mfma_f32_16x16x32_bf16 v[128:131], v[84:87], v[52:55], v[128:131]
v_mfma_f32_16x16x32_bf16 v[132:135], v[116:119], v[52:55], v[132:135]
s_waitcnt lgkmcnt(1)
v_mfma_f32_16x16x32_bf16 v[128:131], v[88:91], v[56:59], v[128:131]
v_mfma_f32_16x16x32_bf16 v[132:135], v[120:123], v[56:59], v[132:135]
s_waitcnt lgkmcnt(0)
v_mfma_f32_16x16x32_bf16 v[128:131], v[92:95], v[60:63], v[128:131]
v_mfma_f32_16x16x32_bf16 v[132:135], v[124:127], v[60:63], v[132:135]
s_nop 7
v_cvt_pk_bf16_f32 v4, v128, v129
v_lshlrev_b32 v128, 16, v4
v_and_b32 v129, 0xffff0000, v4
v_cvt_pk_bf16_f32 v4, v130, v131
v_lshlrev_b32 v130, 16, v4
v_and_b32 v131, 0xffff0000, v4
v_cvt_pk_bf16_f32 v4, v132, v133
v_lshlrev_b32 v132, 16, v4
v_and_b32 v133, 0xffff0000, v4
v_cvt_pk_bf16_f32 v4, v134, v135
v_lshlrev_b32 v134, 16, v4
v_and_b32 v135, 0xffff0000, v4
v_max3_f32 v4, v128, v129, v130
v_max3_f32 v4, v4, v131, v132
v_max3_f32 v4, v4, v133, v134
v_max_f32 v4, v4, v135
v_mov_b32 v5, v4
s_nop 1
v_permlane16_swap_b32 v4, v5
s_nop 0
v_max_f32 v4, v4, v5
v_mov_b32 v5, v4
s_nop 1
v_permlane32_swap_b32 v4, v5
s_nop 0
v_max_f32 v4, v4, v5
v_mul_f32 v6, s65, v4
v_fma_f32 v128, v128, s65, -v6
v_fma_f32 v129, v129, s65, -v6
v_fma_f32 v130, v130, s65, -v6
v_fma_f32 v131, v131, s65, -v6
v_fma_f32 v132, v132, s65, -v6
v_fma_f32 v133, v133, s65, -v6
v_fma_f32 v134, v134, s65, -v6
v_fma_f32 v135, v135, s65, -v6
v_exp_f32 v128, v128
v_exp_f32 v129, v129
v_exp_f32 v130, v130
v_exp_f32 v131, v131
v_exp_f32 v132, v132
v_exp_f32 v133, v133
v_exp_f32 v134, v134
v_exp_f32 v135, v135
s_nop 0
v_add_f32 v5, v128, v129
v_add_f32 v6, v130, v131
v_add_f32 v7, v132, v133
v_add_f32 v140, v134, v135
v_add_f32 v5, v5, v6
v_add_f32 v7, v7, v140
v_cvt_pk_bf16_f32 v136, v128, v129
v_cvt_pk_bf16_f32 v137, v130, v131
v_cvt_pk_bf16_f32 v138, v132, v133
v_cvt_pk_bf16_f32 v139, v134, v135
v_add_f32 v5, v5, v7
v_mov_b32 v6, v5
s_nop 1
v_permlane16_swap_b32 v5, v6
s_nop 0
v_add_f32 v5, v5, v6
v_mov_b32 v6, v5
s_nop 1
v_permlane32_swap_b32 v5, v6
s_nop 0
v_add_f32 v5, v5, v6
s_mov_b32 exec_lo, 0x00030003
s_mov_b32 exec_hi, 0x00030003
ds_write_b128 v30, v[136:139]
s_mov_b64 exec, 3
s_lshl_b32 s60, s30, 4
v_add_u32 v6, s60, v31
ds_write_b64 v6, v[4:5]
s_waitcnt lgkmcnt(0)
s_mov_b64 exec, 1
v_mov_b32 v14, 1
ds_add_u32 v15, v14 offset:24
s_mov_b64 exec, -1
L_wl_28:
ds_read_b32 v14, v15 offset:24
s_waitcnt lgkmcnt(0)
v_readfirstlane_b32 s58, v14
s_cmp_ge_u32 s58, 4
s_cbranch_scc1 L_wld_29
s_sleep 1
s_add_u32 s59, s59, 1
s_bitcmp1_b32 s59, 22
s_cbranch_scc0 L_wl_28
s_branch L_end
L_wld_29:
ds_read_b64 v[140:141], v31 offset:0
ds_read_b64 v[142:143], v31 offset:16
ds_read_b64 v[144:145], v31 offset:32
ds_read_b64 v[146:147], v31 offset:48
ds_read_b128 v[160:163], v20 offset:0
ds_read_b128 v[164:167], v21 offset:0
ds_read_b128 v[168:171], v22 offset:0
ds_read_b128 v[172:175], v23 offset:0
ds_read_b128 v[176:179], v20 offset:128
ds_read_b128 v[180:183], v21 offset:128
ds_read_b128 v[184:187], v22 offset:128
ds_read_b128 v[188:191], v23 offset:128
ds_read_b128 v[192:195], v20 offset:256
ds_read_b128 v[196:199], v21 offset:256
ds_read_b128 v[200:203], v22 offset:256
ds_read_b128 v[204:207], v23 offset:256
ds_read_b128 v[208:211], v20 offset:384
ds_read_b128 v[212:215], v21 offset:384
ds_read_b128 v[216:219], v22 offset:384
ds_read_b128 v[220:223], v23 offset:384
s_waitcnt lgkmcnt(0)
v_max3_f32 v4, v140, v142, v144
v_max_f32 v4, v4, v146
v_sub_f32 v148, v140, v4
v_mul_f32 v148, s65, v148
v_sub_f32 v149, v142, v4
v_mul_f32 v149, s65, v149
v_sub_f32 v150, v144, v4
v_mul_f32 v150, s65, v150
v_sub_f32 v151, v146, v4
v_mul_f32 v151, s65, v151
v_exp_f32 v148, v148
v_exp_f32 v149, v149
v_exp_f32 v150, v150
v_exp_f32 v151, v151
s_nop 0
v_mul_f32 v6, v148, v141
v_fmac_f32 v6, v149, v143
v_fmac_f32 v6, v150, v145
v_fmac_f32 v6, v151, v147
s_cmp_lg_u32 s30, 0
s_cbranch_scc1 L_nostat_30
v_mov_b32 v5, s33
v_mov_b32 v7, s33
v_lshlrev_b32 v152, 9, v0
s_lshl_b32 s60, s31, 10
s_lshl_b32 s61, s32, 4
s_add_u32 s60, s60, s61
s_add_u32 s60, s60, 458752
v_add_u32 v152, s60, v152
s_mov_b64 exec, 3
global_store_dwordx4 v152, v[4:7], s[28:29]
s_cmp_eq_u32 s35, 4
s_cbranch_scc1 L_ns_31
v_add_u32 v152, 0x1000000, v152
global_store_dwordx4 v152, v[4:7], s[28:29] sc1
L_ns_31:
s_mov_b64 exec, -1
v_mov_b32 v14, 1
ds_write_b32 v15, v14 offset:36
L_nostat_30:
v_lshrrev_b32 v4, 2, v0
v_lshlrev_b32 v27, 2, v4
v_lshlrev_b32 v4, 11, v4
v_and_b32 v5, 3, v0
v_lshl_add_u32 v4, v5, 4, v4
s_lshl_b32 s60, s31, 16
s_lshl_b32 s61, s32, 6
s_add_u32 s60, s60, s61
s_add_u32 s60, s60, 1048576
s_cmp_eq_u32 s35, 4
s_cselect_b32 s61, 0, 0x1000000
s_add_u32 s60, s60, s61
v_add_u32 v25, s60, v4
v_add_u32 v26, 32768, v25
v_add_u32 v27, 158912, v27
L_wl_32:
ds_read_b32 v14, v15 offset:4
s_waitcnt lgkmcnt(0)
v_readfirstlane_b32 s58, v14
s_cmp_ge_u32 s58, 1
s_cbranch_scc1 L_wld_33
s_sleep 3
s_add_u32 s59, s59, 1
s_bitcmp1_b32 s59, 22
s_cbranch_scc0 L_wl_32
s_branch L_end
L_wld_33:
ds_read_b64_tr_b16 v[64:65], v16 offset:0
ds_read_b64_tr_b16 v[66:67], v16 offset:8192
ds_read_b64_tr_b16 v[68:69], v17 offset:0
ds_read_b64_tr_b16 v[70:71], v17 offset:8192
ds_read_b64_tr_b16 v[72:73], v18 offset:0
ds_read_b64_tr_b16 v[74:75], v18 offset:8192
ds_read_b64_tr_b16 v[76:77], v19 offset:0
ds_read_b64_tr_b16 v[78:79], v19 offset:8192
s_waitcnt lgkmcnt(6)
v_mfma_f32_16x16x32_bf16 v[224:227], v[64:67], v[160:163], 0
s_waitcnt lgkmcnt(4)
v_mfma_f32_16x16x32_bf16 v[224:227], v[68:71], v[164:167], v[224:227]
s_waitcnt lgkmcnt(2)
v_mfma_f32_16x16x32_bf16 v[224:227], v[72:75], v[168:171], v[224:227]
s_waitcnt lgkmcnt(0)
v_mfma_f32_16x16x32_bf16 v[224:227], v[76:79], v[172:175], v[224:227]
L_wl_34:
ds_read_b32 v14, v15 offset:4
s_waitcnt lgkmcnt(0)
v_readfirstlane_b32 s58, v14
s_cmp_ge_u32 s58, 2
s_cbranch_scc1 L_wld_35
s_sleep 3
s_add_u32 s59, s59, 1
s_bitcmp1_b32 s59, 22
s_cbranch_scc0 L_wl_34
s_branch L_end
L_wld_35:
ds_read_b64_tr_b16 v[64:65], v16 offset:16384
ds_read_b64_tr_b16 v[66:67], v16 offset:24576
ds_read_b64_tr_b16 v[68:69], v17 offset:16384
ds_read_b64_tr_b16 v[70:71], v17 offset:24576
ds_read_b64_tr_b16 v[72:73], v18 offset:16384
ds_read_b64_tr_b16 v[74:75], v18 offset:24576
ds_read_b64_tr_b16 v[76:77], v19 offset:16384
ds_read_b64_tr_b16 v[78:79], v19 offset:24576
s_waitcnt lgkmcnt(6)
v_mfma_f32_16x16x32_bf16 v[228:231], v[64:67], v[176:179], 0
s_waitcnt lgkmcnt(4)
v_mfma_f32_16x16x32_bf16 v[228:231], v[68:71], v[180:183], v[228:231]
s_waitcnt lgkmcnt(2)
v_mfma_f32_16x16x32_bf16 v[228:231], v[72:75], v[184:187], v[228:231]
s_waitcnt lgkmcnt(0)
v_mfma_f32_16x16x32_bf16 v[228:231], v[76:79], v[188:191], v[228:231]
L_wl_36:
ds_read_b32 v14, v15 offset:4
s_waitcnt lgkmcnt(0)
v_readfirstlane_b32 s58, v14
s_cmp_ge_u32 s58, 3
s_cbranch_scc1 L_wld_37
s_sleep 3
s_add_u32 s59, s59, 1
s_bitcmp1_b32 s59, 22
s_cbranch_scc0 L_wl_36
s_branch L_end
L_wld_37:
ds_read_b64_tr_b16 v[64:65], v16 offset:32768
ds_read_b64_tr_b16 v[66:67], v16 offset:40960
ds_read_b64_tr_b16 v[68:69], v17 offset:32768
ds_read_b64_tr_b16 v[70:71], v17 offset:40960
ds_read_b64_tr_b16 v[72:73], v18 offset:32768
ds_read_b64_tr_b16 v[74:75], v18 offset:40960
ds_read_b64_tr_b16 v[76:77], v19 offset:32768
ds_read_b64_tr_b16 v[78:79], v19 offset:40960
s_waitcnt lgkmcnt(6)
v_mfma_f32_16x16x32_bf16 v[232:235], v[64:67], v[192:195], 0
s_waitcnt lgkmcnt(4)
v_mfma_f32_16x16x32_bf16 v[232:235], v[68:71], v[196:199], v[232:235]
s_waitcnt lgkmcnt(2)
v_mfma_f32_16x16x32_bf16 v[232:235], v[72:75], v[200:203], v[232:235]
s_waitcnt lgkmcnt(0)
v_mfma_f32_16x16x32_bf16 v[232:235], v[76:79], v[204:207], v[232:235]
s_nop 7
v_mul_f32 v152, v148, v224
v_fmac_f32 v152, v149, v228
v_fmac_f32 v152, v150, v232
v_mul_f32 v153, v148, v225
v_fmac_f32 v153, v149, v229
v_fmac_f32 v153, v150, v233
v_mul_f32 v154, v148, v226
v_fmac_f32 v154, v149, v230
v_fmac_f32 v154, v150, v234
v_mul_f32 v155, v148, v227
v_fmac_f32 v155, v149, v231
v_fmac_f32 v155, v150, v235
s_mov_b32 s60, 0x05030201
s_mov_b32 s61, 0x06050302
s_mov_b32 s62, 0x07060503
L_wf_38:
ds_read_b32 v14, v15 offset:4
s_waitcnt lgkmcnt(0)
v_readfirstlane_b32 s58, v14
s_cmp_ge_u32 s58, 4
s_cbranch_scc1 L_wfd_39
ds_read_b32 v14, v15 offset:4
s_waitcnt lgkmcnt(0)
v_readfirstlane_b32 s58, v14
s_cmp_ge_u32 s58, 4
s_cbranch_scc1 L_wfd_39
ds_read_b32 v14, v15 offset:4
s_waitcnt lgkmcnt(0)
v_readfirstlane_b32 s58, v14
s_cmp_ge_u32 s58, 4
s_cbranch_scc1 L_wfd_39
ds_read_b32 v14, v15 offset:4
s_waitcnt lgkmcnt(0)
v_readfirstlane_b32 s58, v14
s_cmp_ge_u32 s58, 4
s_cbranch_scc1 L_wfd_39
s_add_u32 s59, s59, 1
s_bitcmp1_b32 s59, 22
s_cbranch_scc0 L_wf_38
s_branch L_end
L_wfd_39:
ds_read_b64_tr_b16 v[64:65], v16 offset:49152
ds_read_b64_tr_b16 v[66:67], v16 offset:57344
ds_read_b64_tr_b16 v[68:69], v17 offset:49152
ds_read_b64_tr_b16 v[70:71], v17 offset:57344
ds_read_b64_tr_b16 v[72:73], v18 offset:49152
ds_read_b64_tr_b16 v[74:75], v18 offset:57344
ds_read_b64_tr_b16 v[76:77], v19 offset:49152
ds_read_b64_tr_b16 v[78:79], v19 offset:57344
s_waitcnt lgkmcnt(6)
v_mfma_f32_16x16x32_bf16 v[236:239], v[64:67], v[208:211], 0
s_waitcnt lgkmcnt(4)
v_mfma_f32_16x16x32_bf16 v[236:239], v[68:71], v[212:215], v[236:239]
s_waitcnt lgkmcnt(2)
v_mfma_f32_16x16x32_bf16 v[236:239], v[72:75], v[216:219], v[236:239]
s_waitcnt lgkmcnt(0)
v_mfma_f32_16x16x32_bf16 v[236:239], v[76:79], v[220:223], v[236:239]
s_mov_b32 exec_lo, 0x00ff00ff
s_mov_b32 exec_hi, 0x00ff00ff
s_nop 5
v_fma_f32 v244, v151, v236, v152
v_fma_f32 v245, v151, v237, v153
v_fma_f32 v246, v151, v238, v154
v_fma_f32 v247, v151, v239, v155
v_add_u32 v244, 0x80, v244
v_add_u32 v245, 0x80, v245
v_add_u32 v246, 0x80, v246
v_add_u32 v247, 0x80, v247
v_perm_b32 v240, v245, v244, s60
v_perm_b32 v241, v246, v245, s61
v_perm_b32 v242, v247, v246, s62
global_store_dwordx4 v12, v[240:243], s[28:29]
s_cmp_eq_u32 s35, 4
s_cbranch_scc1 L_ns_40
global_store_dwordx4 v13, v[240:243], s[28:29] sc1
L_ns_40:
s_mov_b64 exec, -1
s_mov_b32 s36, 0x05030201
s_mov_b32 s37, 0x06050302
s_mov_b32 s38, 0x07060503
s_mov_b32 s60, 0x05040100
s_mov_b32 s61, 0x07060302
v_mov_b32 v232, 0
v_mov_b32 v234, 0
v_mov_b32 v236, 0
v_mov_b32 v238, 0
v_mov_b32 v233, s33
v_mov_b32 v235, s33
L_wl_41:
ds_read_b32 v14, v15 offset:20
s_waitcnt lgkmcnt(0)
v_readfirstlane_b32 s58, v14
s_cmp_ge_u32 s58, 1
s_cbranch_scc1 L_wld_42
s_sleep 1
s_add_u32 s59, s59, 1
s_bitcmp1_b32 s59, 22
s_cbranch_scc0 L_wl_41
s_branch L_end
L_wld_42:
v_mov_b32 v4, 158784
ds_read_b128 v[156:159], v4
L_wf_43:
ds_read_b32 v14, v15 offset:8
s_waitcnt lgkmcnt(0)
v_readfirstlane_b32 s58, v14
s_cmp_ge_u32 s58, 1
s_cbranch_scc1 L_wfd_44
ds_read_b32 v14, v15 offset:8
s_waitcnt lgkmcnt(0)
v_readfirstlane_b32 s58, v14
s_cmp_ge_u32 s58, 1
s_cbranch_scc1 L_wfd_44
ds_read_b32 v14, v15 offset:8
s_waitcnt lgkmcnt(0)
v_readfirstlane_b32 s58, v14
s_cmp_ge_u32 s58, 1
s_cbranch_scc1 L_wfd_44
ds_read_b32 v14, v15 offset:8
s_waitcnt lgkmcnt(0)
v_readfirstlane_b32 s58, v14
s_cmp_ge_u32 s58, 1
s_cbranch_scc1 L_wfd_44
s_add_u32 s59, s59, 1
s_bitcmp1_b32 s59, 22
s_cbranch_scc0 L_wf_43
s_branch L_end
L_wfd_44:
global_load_dwordx4 v[64:67], v25, s[28:29] sc1
global_load_dwordx4 v[68:71], v26, s[28:29] sc1
ds_read2st64_b32 v[112:113], v28 offset0:64 offset1:68
ds_read2st64_b32 v[114:115], v28 offset0:72 offset1:76
ds_read2st64_b32 v[116:117], v28 offset0:80 offset1:84
ds_read2st64_b32 v[118:119], v28 offset0:88 offset1:92
ds_read2st64_b32 v[96:97], v28 offset0:0 offset1:4
ds_read2st64_b32 v[98:99], v28 offset0:8 offset1:12
ds_read2st64_b32 v[100:101], v28 offset0:16 offset1:20
ds_read2st64_b32 v[102:103], v28 offset0:24 offset1:28
ds_read2st64_b32 v[104:105], v28 offset0:32 offset1:36
ds_read2st64_b32 v[106:107], v28 offset0:40 offset1:44
ds_read2st64_b32 v[108:109], v28 offset0:48 offset1:52
ds_read2st64_b32 v[110:111], v28 offset0:56 offset1:60
ds_read_b32 v90, v15 offset:44
ds_read_b32 v88, v27
ds_read_b32 v89, v27 offset:64
s_waitcnt lgkmcnt(14)
v_perm_b32 v136, v113, v112, s60
v_perm_b32 v152, v113, v112, s61
s_waitcnt lgkmcnt(13)
v_perm_b32 v137, v115, v114, s60
v_perm_b32 v153, v115, v114, s61
s_waitcnt lgkmcnt(12)
v_perm_b32 v138, v117, v116, s60
v_perm_b32 v154, v117, v116, s61
s_waitcnt lgkmcnt(11)
v_perm_b32 v139, v119, v118, s60
v_perm_b32 v155, v119, v118, s61
s_waitcnt lgkmcnt(10)
v_perm_b32 v128, v97, v96, s60
v_perm_b32 v144, v97, v96, s61
v_dot2_f32_bf16 v232, v136, v156, v232
v_dot2_f32_bf16 v234, v152, v156, v234
s_waitcnt lgkmcnt(9)
v_perm_b32 v129, v99, v98, s60
v_perm_b32 v145, v99, v98, s61
v_dot2_f32_bf16 v236, v137, v157, v236
v_dot2_f32_bf16 v238, v153, v157, v238
s_waitcnt lgkmcnt(8)
v_perm_b32 v130, v101, v100, s60
v_perm_b32 v146, v101, v100, s61
v_dot2_f32_bf16 v232, v138, v158, v232
v_dot2_f32_bf16 v234, v154, v158, v234
s_waitcnt lgkmcnt(7)
v_perm_b32 v131, v103, v102, s60
v_perm_b32 v147, v103, v102, s61
v_dot2_f32_bf16 v236, v139, v159, v236
v_dot2_f32_bf16 v238, v155, v159, v238
s_waitcnt lgkmcnt(6)
v_perm_b32 v132, v105, v104, s60
v_perm_b32 v148, v105, v104, s61
s_waitcnt lgkmcnt(5)
v_perm_b32 v133, v107, v106, s60
v_perm_b32 v149, v107, v106, s61
s_waitcnt lgkmcnt(4)
v_perm_b32 v134, v109, v108, s60
v_perm_b32 v150, v109, v108, s61
s_waitcnt lgkmcnt(3)
v_perm_b32 v135, v111, v110, s60
v_perm_b32 v151, v111, v110, s61
s_mov_b32 s60, 0x0504030c
s_mov_b32 s61, 0x0403020c
s_mov_b32 s68, 0
s_waitcnt vmcnt(0)
s_branch L_pc_46
L_pl_45:
global_load_dwordx4 v[64:67], v25, s[28:29] sc1
global_load_dwordx4 v[68:71], v26, s[28:29] sc1
s_waitcnt vmcnt(0)
L_pc_46:
v_cmp_ne_u32 vcc, s33, v67
s_mov_b64 s[62:63], vcc
v_cmp_ne_u32 vcc, s33, v71
s_or_b64 s[62:63], s[62:63], vcc
s_and_b64 exec, s[62:63], s[62:63]
s_cbranch_scc0 L_pd_47
s_add_u32 s68, s68, 1
s_cmp_lt_u32 s68, 12
s_cbranch_scc1 L_pn_48
v_xor_b32 v25, 0x1000000, v25
v_xor_b32 v26, 0x1000000, v26
L_pn_48:
s_add_u32 s59, s59, 1
s_bitcmp1_b32 s59, 22
s_cbranch_scc0 L_pl_45
s_branch L_end
L_pd_47:
s_mov_b64 exec, -1
v_lshlrev_b32 v72, 8, v64
v_perm_b32 v73, v65, v64, s60
v_perm_b32 v74, v66, v65, s61
v_and_b32 v75, 0xffffff00, v66
v_lshlrev_b32 v76, 8, v68
v_perm_b32 v77, v69, v68, s60
v_perm_b32 v78, v70, v69, s61
v_and_b32 v79, 0xffffff00, v70
s_waitcnt lgkmcnt(0)
v_readfirstlane_b32 s58, v90
s_cmp_ge_u32 s58, 1
s_cbranch_scc1 L_fwd_50
L_fw_49:
ds_read_b32 v14, v15 offset:44
ds_read_b32 v88, v27
ds_read_b32 v89, v27 offset:64
s_waitcnt lgkmcnt(0)
v_readfirstlane_b32 s58, v14
s_cmp_ge_u32 s58, 1
s_cbranch_scc1 L_fwd_50
s_add_u32 s59, s59, 1
s_bitcmp1_b32 s59, 22
s_cbranch_scc0 L_fw_49
s_branch L_end
L_fwd_50:
v_mul_f32 v72, v88, v72
v_mul_f32 v73, v88, v73
v_mul_f32 v74, v88, v74
v_mul_f32 v75, v88, v75
v_fmac_f32 v72, v89, v76
v_fmac_f32 v73, v89, v77
v_fmac_f32 v74, v89, v78
v_fmac_f32 v75, v89, v79
s_nop 0
v_permlane32_swap_b32 v72, v74
v_permlane32_swap_b32 v73, v75
s_nop 0
v_add_f32 v72, v72, v74
v_add_f32 v73, v73, v75
s_nop 1
v_permlane16_swap_b32 v72, v73
s_nop 0
v_add_f32 v72, v72, v73
s_nop 1
v_add_f32_dpp v72, v72, v72 row_ror:4 row_mask:0xf bank_mask:0xf
s_nop 1
v_add_f32_dpp v72, v72, v72 row_ror:8 row_mask:0xf bank_mask:0xf
v_mov_b32 v73, v72
s_nop 1
v_permlane16_swap_b32 v72, v73
s_nop 0
v_cvt_pk_bf16_f32 v88, v72, v73
s_nop 0
v_readlane_b32 s4, v88, 0
v_readlane_b32 s5, v88, 32
v_readlane_b32 s6, v88, 1
v_readlane_b32 s7, v88, 33
v_readlane_b32 s8, v88, 2
v_readlane_b32 s9, v88, 34
v_readlane_b32 s10, v88, 3
v_readlane_b32 s11, v88, 35
s_nop 0
v_dot2_f32_bf16 v232, v128, s4, v232
v_dot2_f32_bf16 v234, v144, s4, v234
v_dot2_f32_bf16 v236, v129, s5, v236
v_dot2_f32_bf16 v238, v145, s5, v238
v_dot2_f32_bf16 v232, v130, s6, v232
v_dot2_f32_bf16 v234, v146, s6, v234
v_dot2_f32_bf16 v236, v131, s7, v236
v_dot2_f32_bf16 v238, v147, s7, v238
v_dot2_f32_bf16 v232, v132, s8, v232
v_dot2_f32_bf16 v234, v148, s8, v234
v_dot2_f32_bf16 v236, v133, s9, v236
v_dot2_f32_bf16 v238, v149, s9, v238
v_dot2_f32_bf16 v232, v134, s10, v232
v_dot2_f32_bf16 v234, v150, s10, v234
v_dot2_f32_bf16 v236, v135, s11, v236
v_dot2_f32_bf16 v238, v151, s11, v238
s_nop 2
v_add_f32 v232, v232, v236
v_add_f32 v234, v234, v238
s_nop 1
v_mov_b32_dpp v236, v232 quad_perm:[1,0,3,2] row_mask:0xf bank_mask:0xf
v_mov_b32_dpp v238, v234 quad_perm:[1,0,3,2] row_mask:0xf bank_mask:0xf
v_add_u32 v232, 0x80, v232
v_add_u32 v234, 0x80, v234
v_add_u32 v236, 0x80, v236
v_add_u32 v238, 0x80, v238
v_perm_b32 v240, v234, v232, s36
v_perm_b32 v241, v236, v234, s37
v_perm_b32 v242, v238, v236, s38
s_mov_b32 exec_lo, 0x55555555
s_mov_b32 exec_hi, 0x00555555
global_store_dwordx4 v29, v[240:243], s[28:29] sc1
s_mov_b64 exec, -1
s_cmp_ge_u32 s32, 7
s_cbranch_scc1 L_fin
v_lshlrev_b32 v254, 16, v254
v_lshlrev_b32 v255, 16, v255
v_add_f32 v254, v254, v255
s_mov_b32 s60, 0x0504030c
s_mov_b32 s61, 0x0403020c
s_waitcnt vmcnt(0)
s_sleep 2
L_pl_51:
global_load_dwordx4 v[64:67], v248, s[28:29] sc1
global_load_dwordx4 v[68:71], v249, s[28:29] sc1
s_waitcnt vmcnt(0)
L_pc_52:
v_cmp_ne_u32 vcc, s33, v67
s_mov_b64 s[62:63], vcc
v_cmp_ne_u32 vcc, s33, v71
s_or_b64 s[62:63], s[62:63], vcc
s_and_b64 exec, s[62:63], s[62:63]
s_cbranch_scc0 L_pd_53
s_sleep 1
s_add_u32 s59, s59, 1
s_bitcmp1_b32 s59, 22
s_cbranch_scc0 L_pl_51
s_branch L_end
L_pd_53:
s_mov_b64 exec, -1
v_lshlrev_b32 v80, 8, v64
v_perm_b32 v81, v65, v64, s60
v_perm_b32 v82, v66, v65, s61
v_and_b32 v83, 0xffffff00, v66
v_lshlrev_b32 v84, 8, v68
v_perm_b32 v85, v69, v68, s60
v_perm_b32 v86, v70, v69, s61
v_and_b32 v87, 0xffffff00, v70
v_add_f32 v80, v80, v84
v_add_f32 v81, v81, v85
v_add_f32 v82, v82, v86
v_add_f32 v83, v83, v87
s_nop 0
v_permlane32_swap_b32 v80, v82
v_permlane32_swap_b32 v81, v83
s_nop 0
v_add_f32 v80, v80, v82
v_add_f32 v81, v81, v83
s_nop 1
v_permlane16_swap_b32 v80, v81
s_nop 0
v_add_f32 v80, v80, v81
s_nop 1
v_add_f32_dpp v80, v80, v80 quad_perm:[2,3,0,1] row_mask:0xf bank_mask:0xf
s_nop 1
v_add_f32_dpp v80, v80, v80 row_ror:4 row_mask:0xf bank_mask:0xf
s_nop 1
v_add_f32_dpp v80, v80, v80 row_ror:8 row_mask:0xf bank_mask:0xf
ds_write_b32 v253, v80
s_waitcnt lgkmcnt(0)
s_barrier
s_cmp_lg_u32 s30, 0
s_cbranch_scc1 L_fin
ds_read_b32 v64, v252 offset:0
ds_read_b32 v65, v252 offset:32
ds_read_b32 v66, v252 offset:64
ds_read_b32 v67, v252 offset:96
s_waitcnt lgkmcnt(0)
v_add_f32 v64, v64, v65
v_add_f32 v66, v66, v67
v_add_f32 v64, v64, v66
v_add_f32 v64, v64, v254
v_mov_b32 v66, v64
s_nop 1
v_permlane16_swap_b32 v64, v66
s_nop 0
v_cvt_pk_bf16_f32 v64, v64, v66
s_mov_b32 exec_lo, 3
s_mov_b32 exec_hi, 3
global_store_dword v24, v64, s[24:25]
s_mov_b64 exec, 1
s_cmp_lg_u32 s2, 0
s_cbranch_scc1 L_fin
v_mov_b32 v4, 0
v_mov_b32 v5, s33
global_store_dword v4, v5, s[28:29] sc1
L_fin:
s_endpgm
L_loader:
v_mov_b32 v4, 0
v_mov_b32 v5, 0
v_mov_b32 v6, 0
v_mov_b32 v7, 0
ds_write_b128 v15, v[4:7] offset:0
ds_write_b128 v15, v[4:7] offset:16
ds_write_b128 v15, v[4:7] offset:32
v_lshlrev_b32 v8, 3, v0
v_add_u32 v8, 158208, v8
ds_write_b64 v8, v[4:5]
v_lshrrev_b32 v1, 5, v0
v_and_b32 v2, 31, v0
v_xor_b32 v3, v2, v1
v_lshlrev_b32 v3, 4, v3
v_lshl_add_u32 v3, v1, 9, v3
v_xor_b32 v16, 0, v3
v_xor_b32 v17, 32, v3
v_xor_b32 v18, 64, v3
v_xor_b32 v19, 96, v3
v_xor_b32 v20, 128, v3
v_xor_b32 v21, 160, v3
v_xor_b32 v22, 192, v3
v_xor_b32 v23, 224, v3
s_lshl_b32 s44, s31, 25
s_add_u32 s44, s44, 0x1e00000
s_lshl_b32 s45, s32, 16
s_add_u32 s44, s44, s45
s_mov_b32 s38, 65536
s_mov_b32 s39, 0x20000
v_lshlrev_b32 v3, 1, v1
v_xor_b32 v3, v2, v3
v_lshlrev_b32 v3, 4, v3
v_lshl_add_u32 v3, v1, 9, v3
v_xor_b32 v24, 0, v3
v_xor_b32 v25, 64, v3
v_xor_b32 v26, 128, v3
v_xor_b32 v27, 192, v3
v_lshlrev_b32 v28, 4, v0
s_mul_i32 s45, s64, 14336
s_min_u32 s46, s64, 223
s_mul_i32 s46, s46, 7168
s_waitcnt lgkmcnt(0)
s_add_u32 s36, s6, s44
s_addc_u32 s37, s7, 0
s_and_b32 s37, s37, 0xffff
s_add_u32 s40, s8, s44
s_addc_u32 s41, s9, 0
s_and_b32 s41, s41, 0xffff
s_mov_b32 s42, 65536
s_mov_b32 s43, 0x20000
s_add_u32 s58, s32, s31
s_and_b32 s58, s58, 3
s_lshl_b32 s58, s58, 12
s_add_u32 s57, s32, s31
s_and_b32 s57, s57, 7
s_lshl_b32 s57, s57, 13
s_add_u32 s48, s12, s45
s_addc_u32 s49, s13, 0
s_and_b32 s49, s49, 0xffff
s_mov_b32 s50, 14336
s_mov_b32 s51, 0x20000
s_add_u32 s52, s20, s46
s_addc_u32 s53, s21, 0
s_and_b32 s53, s53, 0xffff
s_mov_b32 s54, 7168
s_mov_b32 s55, 0x20000
s_cmp_eq_u32 s31, 7
s_cselect_b32 s54, 0, s54
s_barrier
s_add_u32 s56, s57, 0
s_and_b32 s56, s56, 0xffff
s_mov_b32 m0, s56
s_nop 0
buffer_load_dwordx4 v16, s[36:39], s56 offen offset:0 nt lds
buffer_load_dwordx4 v17, s[36:39], s56 offen offset:1024 nt lds
buffer_load_dwordx4 v18, s[36:39], s56 offen offset:2048 nt lds
buffer_load_dwordx4 v19, s[36:39], s56 offen offset:3072 nt lds
s_add_u32 s56, s57, 4096
s_and_b32 s56, s56, 0xffff
s_mov_b32 m0, s56
s_nop 0
buffer_load_dwordx4 v20, s[36:39], s56 offen offset:0 nt lds
buffer_load_dwordx4 v21, s[36:39], s56 offen offset:1024 nt lds
buffer_load_dwordx4 v22, s[36:39], s56 offen offset:2048 nt lds
buffer_load_dwordx4 v23, s[36:39], s56 offen offset:3072 nt lds
s_add_u32 s56, s57, 8192
s_and_b32 s56, s56, 0xffff
s_mov_b32 m0, s56
s_nop 0
buffer_load_dwordx4 v16, s[36:39], s56 offen offset:0 nt lds
buffer_load_dwordx4 v17, s[36:39], s56 offen offset:1024 nt lds
buffer_load_dwordx4 v18, s[36:39], s56 offen offset:2048 nt lds
buffer_load_dwordx4 v19, s[36:39], s56 offen offset:3072 nt lds
s_add_u32 s56, s57, 12288
s_and_b32 s56, s56, 0xffff
s_mov_b32 m0, s56
s_nop 0
buffer_load_dwordx4 v20, s[36:39], s56 offen offset:0 nt lds
buffer_load_dwordx4 v21, s[36:39], s56 offen offset:1024 nt lds
buffer_load_dwordx4 v22, s[36:39], s56 offen offset:2048 nt lds
buffer_load_dwordx4 v23, s[36:39], s56 offen offset:3072 nt lds
s_add_u32 s56, s57, 16384
s_and_b32 s56, s56, 0xffff
s_mov_b32 m0, s56
s_nop 0
buffer_load_dwordx4 v16, s[36:39], s56 offen offset:0 nt lds
buffer_load_dwordx4 v17, s[36:39], s56 offen offset:1024 nt lds
buffer_load_dwordx4 v18, s[36:39], s56 offen offset:2048 nt lds
buffer_load_dwordx4 v19, s[36:39], s56 offen offset:3072 nt lds
s_add_u32 s56, s57, 20480
s_and_b32 s56, s56, 0xffff
s_mov_b32 m0, s56
s_nop 0
buffer_load_dwordx4 v20, s[36:39], s56 offen offset:0 nt lds
buffer_load_dwordx4 v21, s[36:39], s56 offen offset:1024 nt lds
buffer_load_dwordx4 v22, s[36:39], s56 offen offset:2048 nt lds
buffer_load_dwordx4 v23, s[36:39], s56 offen offset:3072 nt lds
s_add_u32 s56, s57, 24576
s_and_b32 s56, s56, 0xffff
s_mov_b32 m0, s56
s_nop 0
buffer_load_dwordx4 v16, s[36:39], s56 offen offset:0 nt lds
buffer_load_dwordx4 v17, s[36:39], s56 offen offset:1024 nt lds
buffer_load_dwordx4 v18, s[36:39], s56 offen offset:2048 nt lds
buffer_load_dwordx4 v19, s[36:39], s56 offen offset:3072 nt lds
s_waitcnt vmcnt(24)
s_add_u32 s56, s57, 28672
s_and_b32 s56, s56, 0xffff
s_mov_b32 m0, s56
s_nop 0
buffer_load_dwordx4 v20, s[36:39], s56 offen offset:0 nt lds
buffer_load_dwordx4 v21, s[36:39], s56 offen offset:1024 nt lds
buffer_load_dwordx4 v22, s[36:39], s56 offen offset:2048 nt lds
buffer_load_dwordx4 v23, s[36:39], s56 offen offset:3072 nt lds
s_waitcnt vmcnt(24)
s_add_u32 s56, s57, 32768
s_and_b32 s56, s56, 0xffff
s_mov_b32 m0, s56
s_nop 0
buffer_load_dwordx4 v16, s[36:39], s56 offen offset:0 nt lds
buffer_load_dwordx4 v17, s[36:39], s56 offen offset:1024 nt lds
buffer_load_dwordx4 v18, s[36:39], s56 offen offset:2048 nt lds
buffer_load_dwordx4 v19, s[36:39], s56 offen offset:3072 nt lds
s_waitcnt vmcnt(24)
s_add_u32 s56, s57, 36864
s_and_b32 s56, s56, 0xffff
s_mov_b32 m0, s56
s_nop 0
buffer_load_dwordx4 v20, s[36:39], s56 offen offset:0 nt lds
buffer_load_dwordx4 v21, s[36:39], s56 offen offset:1024 nt lds
buffer_load_dwordx4 v22, s[36:39], s56 offen offset:2048 nt lds
buffer_load_dwordx4 v23, s[36:39], s56 offen offset:3072 nt lds
s_waitcnt vmcnt(24)
s_add_u32 s56, s57, 40960
s_and_b32 s56, s56, 0xffff
s_mov_b32 m0, s56
s_nop 0
buffer_load_dwordx4 v16, s[36:39], s56 offen offset:0 nt lds
buffer_load_dwordx4 v17, s[36:39], s56 offen offset:1024 nt lds
buffer_load_dwordx4 v18, s[36:39], s56 offen offset:2048 nt lds
buffer_load_dwordx4 v19, s[36:39], s56 offen offset:3072 nt lds
s_waitcnt vmcnt(24)
s_add_u32 s56, s57, 45056
s_and_b32 s56, s56, 0xffff
s_mov_b32 m0, s56
s_nop 0
buffer_load_dwordx4 v20, s[36:39], s56 offen offset:0 nt lds
buffer_load_dwordx4 v21, s[36:39], s56 offen offset:1024 nt lds
buffer_load_dwordx4 v22, s[36:39], s56 offen offset:2048 nt lds
buffer_load_dwordx4 v23, s[36:39], s56 offen offset:3072 nt lds
s_waitcnt vmcnt(24)
s_add_u32 s56, s57, 49152
s_and_b32 s56, s56, 0xffff
s_mov_b32 m0, s56
s_nop 0
buffer_load_dwordx4 v16, s[36:39], s56 offen offset:0 nt lds
buffer_load_dwordx4 v17, s[36:39], s56 offen offset:1024 nt lds
buffer_load_dwordx4 v18, s[36:39], s56 offen offset:2048 nt lds
buffer_load_dwordx4 v19, s[36:39], s56 offen offset:3072 nt lds
s_waitcnt vmcnt(24)
s_add_u32 s56, s57, 53248
s_and_b32 s56, s56, 0xffff
s_mov_b32 m0, s56
s_nop 0
buffer_load_dwordx4 v20, s[36:39], s56 offen offset:0 nt lds
buffer_load_dwordx4 v21, s[36:39], s56 offen offset:1024 nt lds
buffer_load_dwordx4 v22, s[36:39], s56 offen offset:2048 nt lds
buffer_load_dwordx4 v23, s[36:39], s56 offen offset:3072 nt lds
s_waitcnt vmcnt(24)
s_add_u32 s56, s57, 57344
s_and_b32 s56, s56, 0xffff
s_mov_b32 m0, s56
s_nop 0
buffer_load_dwordx4 v16, s[36:39], s56 offen offset:0 nt lds
buffer_load_dwordx4 v17, s[36:39], s56 offen offset:1024 nt lds
buffer_load_dwordx4 v18, s[36:39], s56 offen offset:2048 nt lds
buffer_load_dwordx4 v19, s[36:39], s56 offen offset:3072 nt lds
s_waitcnt vmcnt(24)
s_add_u32 s56, s57, 61440
s_and_b32 s56, s56, 0xffff
s_mov_b32 m0, s56
s_nop 0
buffer_load_dwordx4 v20, s[36:39], s56 offen offset:0 nt lds
buffer_load_dwordx4 v21, s[36:39], s56 offen offset:1024 nt lds
buffer_load_dwordx4 v22, s[36:39], s56 offen offset:2048 nt lds
buffer_load_dwordx4 v23, s[36:39], s56 offen offset:3072 nt lds
s_waitcnt vmcnt(24)
s_add_u32 s56, s58, 0
s_and_b32 s56, s56, 0x3fff
s_add_u32 s56, s56, 0
s_add_u32 m0, s56, 65536
s_nop 0
buffer_load_dwordx4 v24, s[40:43], s56 offen offset:0 nt lds
buffer_load_dwordx4 v25, s[40:43], s56 offen offset:1024 nt lds
buffer_load_dwordx4 v26, s[40:43], s56 offen offset:2048 nt lds
buffer_load_dwordx4 v27, s[40:43], s56 offen offset:3072 nt lds
s_waitcnt vmcnt(24)
s_add_u32 s56, s58, 4096
s_and_b32 s56, s56, 0x3fff
s_add_u32 s56, s56, 0
s_add_u32 m0, s56, 65536
s_nop 0
buffer_load_dwordx4 v24, s[40:43], s56 offen offset:0 nt lds
buffer_load_dwordx4 v25, s[40:43], s56 offen offset:1024 nt lds
buffer_load_dwordx4 v26, s[40:43], s56 offen offset:2048 nt lds
buffer_load_dwordx4 v27, s[40:43], s56 offen offset:3072 nt lds
s_waitcnt vmcnt(24)
s_add_u32 s56, s58, 8192
s_and_b32 s56, s56, 0x3fff
s_add_u32 s56, s56, 0
s_add_u32 m0, s56, 65536
s_nop 0
buffer_load_dwordx4 v24, s[40:43], s56 offen offset:0 nt lds
buffer_load_dwordx4 v25, s[40:43], s56 offen offset:1024 nt lds
buffer_load_dwordx4 v26, s[40:43], s56 offen offset:2048 nt lds
buffer_load_dwordx4 v27, s[40:43], s56 offen offset:3072 nt lds
s_waitcnt vmcnt(24)
s_add_u32 s56, s58, 12288
s_and_b32 s56, s56, 0x3fff
s_add_u32 s56, s56, 0
s_add_u32 m0, s56, 65536
s_nop 0
buffer_load_dwordx4 v24, s[40:43], s56 offen offset:0 nt lds
buffer_load_dwordx4 v25, s[40:43], s56 offen offset:1024 nt lds
buffer_load_dwordx4 v26, s[40:43], s56 offen offset:2048 nt lds
buffer_load_dwordx4 v27, s[40:43], s56 offen offset:3072 nt lds
s_waitcnt vmcnt(24)
s_add_u32 s56, s58, 0
s_and_b32 s56, s56, 0x3fff
s_add_u32 s56, s56, 16384
s_add_u32 m0, s56, 65536
s_nop 0
buffer_load_dwordx4 v24, s[40:43], s56 offen offset:0 nt lds
buffer_load_dwordx4 v25, s[40:43], s56 offen offset:1024 nt lds
buffer_load_dwordx4 v26, s[40:43], s56 offen offset:2048 nt lds
buffer_load_dwordx4 v27, s[40:43], s56 offen offset:3072 nt lds
s_waitcnt vmcnt(24)
s_add_u32 s56, s58, 4096
s_and_b32 s56, s56, 0x3fff
s_add_u32 s56, s56, 16384
s_add_u32 m0, s56, 65536
s_nop 0
buffer_load_dwordx4 v24, s[40:43], s56 offen offset:0 nt lds
buffer_load_dwordx4 v25, s[40:43], s56 offen offset:1024 nt lds
buffer_load_dwordx4 v26, s[40:43], s56 offen offset:2048 nt lds
buffer_load_dwordx4 v27, s[40:43], s56 offen offset:3072 nt lds
s_waitcnt vmcnt(24)
v_mov_b32 v14, 1
ds_write_b32 v15, v14 offset:0
s_add_u32 s56, s58, 8192
s_and_b32 s56, s56, 0x3fff
s_add_u32 s56, s56, 16384
s_add_u32 m0, s56, 65536
s_nop 0
buffer_load_dwordx4 v24, s[40:43], s56 offen offset:0 nt lds
buffer_load_dwordx4 v25, s[40:43], s56 offen offset:1024 nt lds
buffer_load_dwordx4 v26, s[40:43], s56 offen offset:2048 nt lds
buffer_load_dwordx4 v27, s[40:43], s56 offen offset:3072 nt lds
s_waitcnt vmcnt(24)
s_add_u32 s56, s58, 12288
s_and_b32 s56, s56, 0x3fff
s_add_u32 s56, s56, 16384
s_add_u32 m0, s56, 65536
s_nop 0
buffer_load_dwordx4 v24, s[40:43], s56 offen offset:0 nt lds
buffer_load_dwordx4 v25, s[40:43], s56 offen offset:1024 nt lds
buffer_load_dwordx4 v26, s[40:43], s56 offen offset:2048 nt lds
buffer_load_dwordx4 v27, s[40:43], s56 offen offset:3072 nt lds
s_waitcnt vmcnt(24)
s_add_u32 s56, s58, 0
s_and_b32 s56, s56, 0x3fff
s_add_u32 s56, s56, 32768
s_add_u32 m0, s56, 65536
s_nop 0
buffer_load_dwordx4 v24, s[40:43], s56 offen offset:0 nt lds
buffer_load_dwordx4 v25, s[40:43], s56 offen offset:1024 nt lds
buffer_load_dwordx4 v26, s[40:43], s56 offen offset:2048 nt lds
buffer_load_dwordx4 v27, s[40:43], s56 offen offset:3072 nt lds
s_waitcnt vmcnt(24)
s_add_u32 s56, s58, 4096
s_and_b32 s56, s56, 0x3fff
s_add_u32 s56, s56, 32768
s_add_u32 m0, s56, 65536
s_nop 0
buffer_load_dwordx4 v24, s[40:43], s56 offen offset:0 nt lds
buffer_load_dwordx4 v25, s[40:43], s56 offen offset:1024 nt lds
buffer_load_dwordx4 v26, s[40:43], s56 offen offset:2048 nt lds
buffer_load_dwordx4 v27, s[40:43], s56 offen offset:3072 nt lds
s_waitcnt vmcnt(24)
v_mov_b32 v14, 1
ds_write_b32 v15, v14 offset:4
s_add_u32 s56, s58, 8192
s_and_b32 s56, s56, 0x3fff
s_add_u32 s56, s56, 32768
s_add_u32 m0, s56, 65536
s_nop 0
buffer_load_dwordx4 v24, s[40:43], s56 offen offset:0 nt lds
buffer_load_dwordx4 v25, s[40:43], s56 offen offset:1024 nt lds
buffer_load_dwordx4 v26, s[40:43], s56 offen offset:2048 nt lds
buffer_load_dwordx4 v27, s[40:43], s56 offen offset:3072 nt lds
s_waitcnt vmcnt(24)
s_add_u32 s56, s58, 12288
s_and_b32 s56, s56, 0x3fff
s_add_u32 s56, s56, 32768
s_add_u32 m0, s56, 65536
s_nop 0
buffer_load_dwordx4 v24, s[40:43], s56 offen offset:0 nt lds
buffer_load_dwordx4 v25, s[40:43], s56 offen offset:1024 nt lds
buffer_load_dwordx4 v26, s[40:43], s56 offen offset:2048 nt lds
buffer_load_dwordx4 v27, s[40:43], s56 offen offset:3072 nt lds
s_waitcnt vmcnt(24)
s_add_u32 s56, s58, 0
s_and_b32 s56, s56, 0x3fff
s_add_u32 s56, s56, 49152
s_add_u32 m0, s56, 65536
s_nop 0
buffer_load_dwordx4 v24, s[40:43], s56 offen offset:0 nt lds
buffer_load_dwordx4 v25, s[40:43], s56 offen offset:1024 nt lds
buffer_load_dwordx4 v26, s[40:43], s56 offen offset:2048 nt lds
buffer_load_dwordx4 v27, s[40:43], s56 offen offset:3072 nt lds
s_waitcnt vmcnt(24)
s_add_u32 s56, s58, 4096
s_and_b32 s56, s56, 0x3fff
s_add_u32 s56, s56, 49152
s_add_u32 m0, s56, 65536
s_nop 0
buffer_load_dwordx4 v24, s[40:43], s56 offen offset:0 nt lds
buffer_load_dwordx4 v25, s[40:43], s56 offen offset:1024 nt lds
buffer_load_dwordx4 v26, s[40:43], s56 offen offset:2048 nt lds
buffer_load_dwordx4 v27, s[40:43], s56 offen offset:3072 nt lds
s_waitcnt vmcnt(24)
v_mov_b32 v14, 2
ds_write_b32 v15, v14 offset:4
s_add_u32 s56, s58, 8192
s_and_b32 s56, s56, 0x3fff
s_add_u32 s56, s56, 49152
s_add_u32 m0, s56, 65536
s_nop 0
buffer_load_dwordx4 v24, s[40:43], s56 offen offset:0 nt lds
buffer_load_dwordx4 v25, s[40:43], s56 offen offset:1024 nt lds
buffer_load_dwordx4 v26, s[40:43], s56 offen offset:2048 nt lds
buffer_load_dwordx4 v27, s[40:43], s56 offen offset:3072 nt lds
s_waitcnt vmcnt(24)
s_add_u32 s56, s58, 12288
s_and_b32 s56, s56, 0x3fff
s_add_u32 s56, s56, 49152
s_add_u32 m0, s56, 65536
s_nop 0
buffer_load_dwordx4 v24, s[40:43], s56 offen offset:0 nt lds
buffer_load_dwordx4 v25, s[40:43], s56 offen offset:1024 nt lds
buffer_load_dwordx4 v26, s[40:43], s56 offen offset:2048 nt lds
buffer_load_dwordx4 v27, s[40:43], s56 offen offset:3072 nt lds
s_waitcnt vmcnt(24)
s_mov_b32 exec_lo, -1
s_mov_b32 exec_hi, 0x00ffffff
s_mov_b32 m0, 147456
s_movk_i32 s56, 0
buffer_load_dwordx4 v28, s[52:55], s56 offen nt lds
s_mov_b32 m0, 148480
s_movk_i32 s56, 896
buffer_load_dwordx4 v28, s[52:55], s56 offen nt lds
s_mov_b32 m0, 149504
s_movk_i32 s56, 1792
buffer_load_dwordx4 v28, s[52:55], s56 offen nt lds
s_mov_b32 m0, 150528
s_movk_i32 s56, 2688
buffer_load_dwordx4 v28, s[52:55], s56 offen nt lds
s_waitcnt vmcnt(24)
s_mov_b64 exec, -1
s_mov_b32 exec_lo, -1
s_mov_b32 exec_hi, 0x00ffffff
s_mov_b32 m0, 151552
s_movk_i32 s56, 3584
buffer_load_dwordx4 v28, s[52:55], s56 offen nt lds
s_mov_b32 m0, 152576
s_movk_i32 s56, 4480
buffer_load_dwordx4 v28, s[52:55], s56 offen nt lds
s_mov_b32 m0, 153600
s_movk_i32 s56, 5376
buffer_load_dwordx4 v28, s[52:55], s56 offen nt lds
s_mov_b32 m0, 154624
s_movk_i32 s56, 6272
buffer_load_dwordx4 v28, s[52:55], s56 offen nt lds
s_waitcnt vmcnt(24)
s_mov_b64 exec, -1
v_mov_b32 v14, 3
ds_write_b32 v15, v14 offset:4
s_mov_b32 exec_lo, -1
s_mov_b32 exec_hi, 0x00ffffff
s_mov_b32 m0, 131072
s_movk_i32 s56, 0
buffer_load_dwordx4 v28, s[48:51], s56 offen nt lds
s_mov_b32 m0, 132096
s_movk_i32 s56, 896
buffer_load_dwordx4 v28, s[48:51], s56 offen nt lds
s_mov_b32 m0, 133120
s_movk_i32 s56, 1792
buffer_load_dwordx4 v28, s[48:51], s56 offen nt lds
s_mov_b32 m0, 134144
s_movk_i32 s56, 2688
buffer_load_dwordx4 v28, s[48:51], s56 offen nt lds
s_waitcnt vmcnt(24)
s_mov_b64 exec, -1
s_mov_b32 exec_lo, -1
s_mov_b32 exec_hi, 0x00ffffff
s_mov_b32 m0, 135168
s_movk_i32 s56, 3584
buffer_load_dwordx4 v28, s[48:51], s56 offen nt lds
s_mov_b32 m0, 136192
s_movk_i32 s56, 4480
buffer_load_dwordx4 v28, s[48:51], s56 offen nt lds
s_mov_b32 m0, 137216
s_movk_i32 s56, 5376
buffer_load_dwordx4 v28, s[48:51], s56 offen nt lds
s_mov_b32 m0, 138240
s_movk_i32 s56, 6272
buffer_load_dwordx4 v28, s[48:51], s56 offen nt lds
s_waitcnt vmcnt(24)
s_mov_b64 exec, -1
s_mov_b32 exec_lo, -1
s_mov_b32 exec_hi, 0x00ffffff
s_mov_b32 m0, 139264
s_movk_i32 s56, 7168
buffer_load_dwordx4 v28, s[48:51], s56 offen nt lds
s_mov_b32 m0, 140288
s_movk_i32 s56, 8064
buffer_load_dwordx4 v28, s[48:51], s56 offen nt lds
s_mov_b32 m0, 141312
s_movk_i32 s56, 8960
buffer_load_dwordx4 v28, s[48:51], s56 offen nt lds
s_mov_b32 m0, 142336
s_movk_i32 s56, 9856
buffer_load_dwordx4 v28, s[48:51], s56 offen nt lds
s_waitcnt vmcnt(24)
s_mov_b64 exec, -1
s_mov_b32 exec_lo, -1
s_mov_b32 exec_hi, 0x00ffffff
s_mov_b32 m0, 143360
s_movk_i32 s56, 10752
buffer_load_dwordx4 v28, s[48:51], s56 offen nt lds
s_mov_b32 m0, 144384
s_movk_i32 s56, 11648
buffer_load_dwordx4 v28, s[48:51], s56 offen nt lds
s_mov_b32 m0, 145408
s_movk_i32 s56, 12544
buffer_load_dwordx4 v28, s[48:51], s56 offen nt lds
s_mov_b32 m0, 146432
s_movk_i32 s56, 13440
buffer_load_dwordx4 v28, s[48:51], s56 offen nt lds
s_mov_b64 exec, -1
s_waitcnt vmcnt(24)
v_mov_b32 v14, 4
ds_write_b32 v15, v14 offset:4
s_waitcnt vmcnt(0)
v_mov_b32 v14, 1
ds_write_b32 v15, v14 offset:8
s_waitcnt lgkmcnt(0)
L_end:
s_endpgm
.section .rodata,"a"
.p2align 6
.amdhsa_kernel parallel_sum__sliding_block_cached__dense_activation_gelu__decode_kernel
  .amdhsa_next_free_vgpr 256
  .amdhsa_next_free_sgpr 102
  .amdhsa_accum_offset 256
  .amdhsa_group_segment_fixed_size 0
  .amdhsa_kernarg_size 104
  .amdhsa_user_sgpr_count 2
  .amdhsa_user_sgpr_kernarg_segment_ptr 1
  .amdhsa_system_sgpr_workgroup_id_x 1
.end_amdhsa_kernel
```
